```python
import torch

def _softmax(x, axis=-1):
    return torch.softmax(x, dim=axis)
def _gelu(x):
    return torch.nn.functional.gelu(x, approximate="tanh")
def _silu(x):
    return torch.nn.functional.silu(x)
def _sigmoid(x):
    return torch.sigmoid(x)
def _layernorm(x, axis=-1, eps=1e-5):
    m = x.mean(dim=axis, keepdim=True)
    v = x.var(dim=axis, keepdim=True, unbiased=False)
    return (x - m) / torch.sqrt(v + eps)
def _scatter_add(tgt, idx, src, axis=0):
    return tgt.clone().index_add_(axis, idx, src)
def _segment_sum(src, seg, n):
    out = torch.zeros((n,) + src.shape[1:], dtype=src.dtype)
    return out.index_add_(0, seg, src)
def _pad(x, pw):
    flat = tuple(v for pair in reversed(pw) for v in pair)
    return torch.nn.functional.pad(x, flat)

kernel_name = 'gated_mix__gqa_block_cached__glu_gated_reglu__decode'

def setup_inputs():

    _w = (lambda a: (lambda t: t.to(torch.bfloat16) if t.is_floating_point() else t)(torch.as_tensor(a)))
    def _A_setup():
        B, Sq, D = 1, 1, 1024
        Hq, Hkv, Sk, Dh = 32, 4, 65536, 128
        assert Hq % Hkv == 0, (Hq, Hkv)
        return {
            "x": _w((lambda *s: torch.randn(*s, dtype=torch.bfloat16) * 0.05)(B, Sq, D)),
            "k_cache": _w((lambda *s: torch.randn(*s, dtype=torch.bfloat16) * 3.2)(B, Hkv, Sk, Dh)),
            "v_cache": _w((lambda *s: torch.randn(*s, dtype=torch.bfloat16) * 1.6)(B, Hkv, Sk, Dh)),
            "wq": _w((lambda *s: torch.randn(*s, dtype=torch.bfloat16) * 3.2)(D, Hq * Dh) * (D ** -0.5)),
            "wo": _w((lambda *s: torch.randn(*s, dtype=torch.bfloat16) * 1.6)(Hq * Dh, D) * ((Hq * Dh) ** -0.5)),
        }
    _A_in = _A_setup()

    def _B_setup():
        B, S, D, F = 1, 1, 1024, 3584
        return {
            "x": _w((lambda *s: torch.randn(*s, dtype=torch.bfloat16) * 0.05)(B, S, D)),
            "W_gate": _w((lambda *s: torch.randn(*s, dtype=torch.bfloat16) * 1.6)(D, F) * (2.0 / D) ** 0.5),
            "W_up": _w((lambda *s: torch.randn(*s, dtype=torch.bfloat16) * 1.6)(D, F) * (2.0 / D) ** 0.5),
            "W_down": _w((lambda *s: torch.randn(*s, dtype=torch.bfloat16) * 1.6)(F, D) * (1.0 / F) ** 0.5),
        }
    _B_in = _B_setup()

    return {
        "A_x": _A_in["x"],
        "A_k_cache": _A_in["k_cache"],
        "A_v_cache": _A_in["v_cache"],
        "A_wq": _A_in["wq"],
        "A_wo": _A_in["wo"],
        "B_x": _B_in["x"],
        "B_W_gate": _B_in["W_gate"],
        "B_W_up": _B_in["W_up"],
        "B_W_down": _B_in["W_down"],
        "gate_w": _w((lambda *s: torch.randn(*s, dtype=torch.bfloat16) * 0.05)(1024) * 16.0),
    }

def reference(A_x, A_k_cache, A_v_cache, A_wq, A_wo, B_x, B_W_gate, B_W_up, B_W_down, gate_w):
    def _A_ref(x, k_cache, v_cache, wq, wo):
        B, Sq, D = x.shape
        Hq, Dh = 32, 128
        Hkv = k_cache.shape[1]
        rep = Hq // Hkv
        q = (lambda x, *d: x.permute(*d))((x @ wq).reshape(B, Sq, Hq, Dh), 0, 2, 1, 3)
        k = (lambda x, n, axis: torch.repeat_interleave(x, n, dim=axis))(k_cache, rep, axis=1)
        v = (lambda x, n, axis: torch.repeat_interleave(x, n, dim=axis))(v_cache, rep, axis=1)
        scores = torch.einsum("bhqd,bhkd->bhqk", q, k) * (Dh ** -0.5)
        p = _softmax(scores, axis=-1)
        o = torch.einsum("bhqk,bhkd->bhqd", p, v)
        return (lambda x, *d: x.permute(*d))(o, 0, 2, 1, 3).reshape(B, Sq, Hq * Dh) @ wo

    def _B_ref(x, W_gate, W_up, W_down):
        gate = torch.einsum("bsd,df->bsf", x, W_gate)
        up = torch.einsum("bsd,df->bsf", x, W_up)
        gate = gate * (lambda x, dt: x.to(dt))(gate > 0, gate.dtype)
        h = gate * up
        return torch.einsum("bsf,fd->bsd", h, W_down)

    x = A_x
    g = _sigmoid((x * gate_w).sum(-1, keepdims=True))
    a = _A_ref(x, A_k_cache, A_v_cache, A_wq, A_wo)
    b = _B_ref(x, B_W_gate, B_W_up, B_W_down)
    return g * a + (1 - g) * b
```

```asm
; @launch grid=(256,1,1) block=(576,1,1) lds=82440
.amdgcn_target "amdgcn-amd-amdhsa--gfx950"
.text
.globl gated_mix__gqa_block_cached__glu_gated_reglu__decode_kernel
.p2align 8
.type gated_mix__gqa_block_cached__glu_gated_reglu__decode_kernel,@function
gated_mix__gqa_block_cached__glu_gated_reglu__decode_kernel:
    s_cmp_ge_u32 s2, 256
    s_cbranch_scc1 L_end
    s_load_dwordx16 s[76:91], s[0:1], 0
    s_load_dwordx8 s[92:99], s[0:1], 64
    s_load_dwordx2 s[40:41], s[0:1], 96
    s_memrealtime s[64:65]
    v_lshrrev_b32 v8, 6, v0
    v_lshlrev_b32 v2, 4, v0
    v_readfirstlane_b32 s3, v8
    v_and_b32 v0, 63, v0
    s_lshr_b32 s48, s2, 6
    s_and_b32 s49, s2, 63
    s_bfe_u32 s70, s2, 0x30003
    s_and_b32 s53, s2, 7
    s_lshl_b32 s54, s48, 1
    s_xor_b32 s53, s53, s54
    s_lshl_b32 s53, s53, 2
    s_or_b32 s71, s53, s48
    s_mov_b32 s34, 2048
    s_mov_b32 s35, 0x20000
    v_lshlrev_b32 v5, 4, v0
    s_cmp_eq_u32 s3, 8
    s_cbranch_scc1 L_comm
    s_mov_b32 s14, 8388608
    s_mov_b32 s15, 0x20000
    v_lshrrev_b32 v8, 4, v0
    v_and_b32 v9, 15, v0
    v_lshlrev_b32 v9, 4, v9
    v_lshl_add_u32 v11, v8, 13, v9
    v_lshlrev_b32 v10, 3, v8
    s_lshl_b32 s56, s70, 3
    s_add_u32 s56, s56, s3
    s_lshl_b32 s53, s71, 8
    s_lshl_b32 s61, s56, 17
    s_add_u32 s61, s61, s53
    s_mul_i32 s62, s56, 114688
    s_add_u32 s62, s62, s53
    s_lshl_b32 s56, s56, 5
    s_add_u32 s53, s61, 32768
    s_add_u32 s54, s61, 65536
    s_add_u32 s55, s61, 98304
    s_waitcnt lgkmcnt(0)
    s_mov_b64 s[12:13], s[82:83]
    s_mov_b64 s[32:33], s[76:77]
    buffer_load_dwordx4 v[128:131], v11, s[12:15], s61 offen nt
    buffer_load_dwordx4 v[132:135], v11, s[12:15], s53 offen nt
    buffer_load_dwordx4 v[136:139], v11, s[12:15], s54 offen nt
    buffer_load_dwordx4 v[140:143], v11, s[12:15], s55 offen nt
    s_load_dwordx8 s[32:39], s[76:77], s56
    v_mul_u32_u24 v7, 7168, v8
    v_mul_u32_u24 v14, 0x202, v8
    v_add_u32 v14, 0x0c0c0100, v14
    v_alignbit_b32 v15, v14, v14, 16
    v_add_u32 v7, v7, v9
    s_cmp_lt_u32 s71, 28
    s_cselect_b32 s22, 7340032, 0
    s_cselect_b32 s26, 7340032, 0
    s_cselect_b32 s30, 7340032, 0
    s_mov_b32 s23, 0x20000
    s_mov_b32 s27, 0x20000
    s_mov_b64 s[20:21], s[88:89]
    s_mov_b64 s[24:25], s[90:91]
    s_mov_b64 s[4:5], s[78:79]
    s_mov_b64 s[8:9], s[80:81]
    s_mov_b64 s[16:17], s[84:85]
    s_mov_b32 s6, 0x4000000
    s_mov_b32 s7, 0x20000
    s_mov_b32 s10, 0x4000000
    s_mov_b32 s11, 0x20000
    s_mov_b32 s18, 8388608
    s_mov_b32 s19, 0x20000
    s_mov_b32 s31, 0x20000
    s_mov_b32 s46, 2048
    s_mov_b32 s47, 0x20000
    s_mov_b32 s57, 0x05040100
    s_mov_b32 s58, 0x07060302
    s_mov_b32 s59, 0x3e0293ee
    s_mov_b32 s67, 3
    s_mul_i32 s52, s48, 20971520
    s_lshl_b32 s53, s49, 16
    s_add_u32 s52, s52, s53
    s_lshl_b32 s53, s3, 13
    s_add_u32 s52, s52, s53
    s_lshl_b32 s53, s3, 10
    s_add_u32 s75, s52, s53
    s_and_b32 s54, s53, 4096
    s_add_u32 s52, s52, s54
    s_and_b32 s53, s53, 3072
    v_lshlrev_b32 v10, 1, v9
    v_lshl_add_u32 v10, v8, 3, v10
    s_lshl_b32 s54, s3, 9
    v_add_u32 v24, s54, v10
    v_and_b32 v10, 3, v0
    v_lshlrev_b32 v10, 10, v10
    v_xor_b32 v10, s53, v10
    v_bfe_u32 v11, v0, 2, 1
    v_lshl_add_u32 v10, v11, 8, v10
    v_bfe_u32 v11, v0, 3, 1
    v_lshl_add_u32 v10, v11, 6, v10
    v_lshl_add_u32 v4, v8, 4, v10
    v_mov_b32 v46, 0
    v_mov_b32 v47, 0x40000000
    s_and_b32 s68, s70, 3
    s_lshr_b32 s69, s70, 2
    s_lshl_b32 s53, s71, 1
    s_or_b32 s69, s69, s53
    s_lshr_b32 s74, s2, 5
    s_lshl_b32 s74, s74, 3
    s_and_b32 s53, s2, 7
    s_or_b32 s74, s74, s53
    s_mov_b32 s42, 2621440
    s_mov_b32 s43, 0x20000
    s_mov_b64 s[28:29], s[92:93]
    s_mov_b64 s[44:45], s[96:97]
    v_mov_b32 v64, 0
    v_mov_b32 v65, 0
    v_mov_b32 v66, 0
    v_mov_b32 v67, 0
    v_mov_b32 v68, 0
    v_mov_b32 v69, 0
    v_mov_b32 v70, 0
    v_mov_b32 v71, 0
    v_mov_b32 v72, 0
    v_mov_b32 v73, 0
    v_mov_b32 v74, 0
    v_mov_b32 v75, 0
    v_mov_b32 v76, 0
    v_mov_b32 v77, 0
    v_mov_b32 v78, 0
    v_mov_b32 v79, 0
    v_mov_b32 v80, 0
    v_mov_b32 v81, 0
    v_mov_b32 v82, 0
    v_mov_b32 v83, 0
    v_mov_b32 v84, 0
    v_mov_b32 v85, 0
    v_mov_b32 v86, 0
    v_mov_b32 v87, 0
    s_barrier
    s_waitcnt vmcnt(3)
    s_waitcnt lgkmcnt(0)
    v_mov_b32 v8, s32
    v_perm_b32 v16, s33, v8, v14
    v_perm_b32 v17, s33, v8, v15
    v_mov_b32 v8, s34
    v_perm_b32 v18, s35, v8, v14
    v_perm_b32 v19, s35, v8, v15
    v_mov_b32 v8, s36
    v_perm_b32 v20, s37, v8, v14
    v_perm_b32 v21, s37, v8, v15
    v_mov_b32 v8, s38
    v_perm_b32 v22, s39, v8, v14
    v_perm_b32 v23, s39, v8, v15
    v_dot2c_f32_bf16 v64, v128, v16
    v_dot2c_f32_bf16 v65, v128, v17
    v_dot2c_f32_bf16 v66, v129, v16
    v_dot2c_f32_bf16 v67, v129, v17
    v_dot2c_f32_bf16 v68, v130, v16
    v_dot2c_f32_bf16 v69, v130, v17
    v_dot2c_f32_bf16 v70, v131, v16
    v_dot2c_f32_bf16 v71, v131, v17
    s_waitcnt vmcnt(2)
    s_add_u32 s56, s62, 0
    buffer_load_dwordx4 v[144:147], v7, s[20:23], s56 offen nt
    v_dot2c_f32_bf16 v64, v132, v18
    v_dot2c_f32_bf16 v65, v132, v19
    v_dot2c_f32_bf16 v66, v133, v18
    v_dot2c_f32_bf16 v67, v133, v19
    v_dot2c_f32_bf16 v68, v134, v18
    v_dot2c_f32_bf16 v69, v134, v19
    v_dot2c_f32_bf16 v70, v135, v18
    v_dot2c_f32_bf16 v71, v135, v19
    s_waitcnt vmcnt(2)
    s_add_u32 s56, s62, 28672
    buffer_load_dwordx4 v[148:151], v7, s[20:23], s56 offen nt
    v_dot2c_f32_bf16 v64, v136, v20
    v_dot2c_f32_bf16 v65, v136, v21
    v_dot2c_f32_bf16 v66, v137, v20
    v_dot2c_f32_bf16 v67, v137, v21
    v_dot2c_f32_bf16 v68, v138, v20
    v_dot2c_f32_bf16 v69, v138, v21
    v_dot2c_f32_bf16 v70, v139, v20
    v_dot2c_f32_bf16 v71, v139, v21
    s_waitcnt vmcnt(2)
    s_add_u32 s56, s62, 57344
    buffer_load_dwordx4 v[152:155], v7, s[20:23], s56 offen nt
    v_dot2c_f32_bf16 v64, v140, v22
    v_dot2c_f32_bf16 v65, v140, v23
    v_dot2c_f32_bf16 v66, v141, v22
    v_dot2c_f32_bf16 v67, v141, v23
    v_dot2c_f32_bf16 v68, v142, v22
    v_dot2c_f32_bf16 v69, v142, v23
    v_dot2c_f32_bf16 v70, v143, v22
    v_dot2c_f32_bf16 v71, v143, v23
    v_permlane32_swap_b32 v64, v68
    v_permlane32_swap_b32 v65, v69
    v_permlane32_swap_b32 v66, v70
    v_permlane32_swap_b32 v67, v71
    v_add_f32 v64, v64, v68
    v_add_f32 v65, v65, v69
    v_add_f32 v66, v66, v70
    v_add_f32 v67, v67, v71
    s_nop 0
    v_permlane16_swap_b32 v64, v66
    v_permlane16_swap_b32 v65, v67
    v_add_f32 v64, v64, v66
    v_add_f32 v65, v65, v67
    ds_write_b64 v24, v[64:65] offset:256
    v_mov_b32 v8, 0
    v_mov_b32 v9, 1
    s_waitcnt lgkmcnt(0)
    s_mov_b64 exec, 1
    ds_add_u32 v8, v9
    s_mov_b64 exec, -1
    s_waitcnt vmcnt(2)
    s_add_u32 s56, s62, 86016
    buffer_load_dwordx4 v[156:159], v7, s[20:23], s56 offen nt
    v_dot2c_f32_bf16 v72, v144, v16
    v_dot2c_f32_bf16 v73, v144, v17
    v_dot2c_f32_bf16 v74, v145, v16
    v_dot2c_f32_bf16 v75, v145, v17
    v_dot2c_f32_bf16 v76, v146, v16
    v_dot2c_f32_bf16 v77, v146, v17
    v_dot2c_f32_bf16 v78, v147, v16
    v_dot2c_f32_bf16 v79, v147, v17
    s_waitcnt vmcnt(2)
    s_add_u32 s56, s62, 0
    buffer_load_dwordx4 v[96:99], v7, s[24:27], s56 offen nt
    v_dot2c_f32_bf16 v72, v148, v18
    v_dot2c_f32_bf16 v73, v148, v19
    v_dot2c_f32_bf16 v74, v149, v18
    v_dot2c_f32_bf16 v75, v149, v19
    v_dot2c_f32_bf16 v76, v150, v18
    v_dot2c_f32_bf16 v77, v150, v19
    v_dot2c_f32_bf16 v78, v151, v18
    v_dot2c_f32_bf16 v79, v151, v19
    s_waitcnt vmcnt(2)
    s_add_u32 s56, s62, 28672
    buffer_load_dwordx4 v[100:103], v7, s[24:27], s56 offen nt
    v_dot2c_f32_bf16 v72, v152, v20
    v_dot2c_f32_bf16 v73, v152, v21
    v_dot2c_f32_bf16 v74, v153, v20
    v_dot2c_f32_bf16 v75, v153, v21
    v_dot2c_f32_bf16 v76, v154, v20
    v_dot2c_f32_bf16 v77, v154, v21
    v_dot2c_f32_bf16 v78, v155, v20
    v_dot2c_f32_bf16 v79, v155, v21
    s_waitcnt vmcnt(2)
    s_cmp_gt_i32 s67, 5
    s_cbranch_scc1 Li_1
    s_waitcnt vmcnt(4)
    s_cmp_gt_i32 s67, 4
    s_cbranch_scc1 Li_1
    s_waitcnt vmcnt(3)
    s_cmp_gt_i32 s67, 3
    s_cbranch_scc1 Li_1
    s_waitcnt vmcnt(2)
Li_1:
    s_add_u32 s56, s62, 57344
    buffer_load_dwordx4 v[104:107], v7, s[24:27], s56 offen nt
    s_cmp_gt_i32 s67, 5
    s_cbranch_scc1 Li_2
    s_waitcnt vmcnt(4)
    s_cmp_gt_i32 s67, 4
    s_cbranch_scc1 Li_2
    s_waitcnt vmcnt(3)
    s_cmp_gt_i32 s67, 3
    s_cbranch_scc1 Li_2
    s_waitcnt vmcnt(2)
Li_2:
    s_add_u32 s56, s62, 86016
    buffer_load_dwordx4 v[108:111], v7, s[24:27], s56 offen nt
    s_cmp_gt_i32 s67, 5
    s_cbranch_scc1 Li_3
    s_waitcnt vmcnt(4)
    s_cmp_gt_i32 s67, 4
    s_cbranch_scc1 Li_3
    s_waitcnt vmcnt(3)
    s_cmp_gt_i32 s67, 3
    s_cbranch_scc1 Li_3
    s_waitcnt vmcnt(2)
Li_3:
    s_xor_b32 s63, s52, 0
    buffer_load_dwordx4 v[112:115], v4, s[4:7], s63 offen offset:0 nt
    s_cmp_gt_i32 s67, 5
    s_cbranch_scc1 Li_4
    s_waitcnt vmcnt(4)
    s_cmp_gt_i32 s67, 4
    s_cbranch_scc1 Li_4
    s_waitcnt vmcnt(3)
    s_cmp_gt_i32 s67, 3
    s_cbranch_scc1 Li_4
    s_waitcnt vmcnt(2)
Li_4:
    buffer_load_dwordx4 v[116:119], v4, s[4:7], s63 offen offset:128 nt
    v_dot2c_f32_bf16 v72, v156, v22
    v_dot2c_f32_bf16 v73, v156, v23
    v_dot2c_f32_bf16 v74, v157, v22
    v_dot2c_f32_bf16 v75, v157, v23
    v_dot2c_f32_bf16 v76, v158, v22
    v_dot2c_f32_bf16 v77, v158, v23
    v_dot2c_f32_bf16 v78, v159, v22
    v_dot2c_f32_bf16 v79, v159, v23
    v_permlane32_swap_b32 v72, v76
    v_permlane32_swap_b32 v73, v77
    v_permlane32_swap_b32 v74, v78
    v_permlane32_swap_b32 v75, v79
    v_add_f32 v72, v72, v76
    v_add_f32 v73, v73, v77
    v_add_f32 v74, v74, v78
    v_add_f32 v75, v75, v79
    s_nop 0
    v_permlane16_swap_b32 v72, v74
    v_permlane16_swap_b32 v73, v75
    v_add_f32 v72, v72, v74
    v_add_f32 v73, v73, v75
    ds_write_b64 v24, v[72:73] offset:4352
    s_waitcnt vmcnt(5)
    s_memrealtime s[36:37]
    s_cmp_gt_i32 s67, 5
    s_cbranch_scc1 Li_5
    s_waitcnt vmcnt(4)
    s_cmp_gt_i32 s67, 4
    s_cbranch_scc1 Li_5
    s_waitcnt vmcnt(3)
    s_cmp_gt_i32 s67, 3
    s_cbranch_scc1 Li_5
    s_waitcnt vmcnt(2)
Li_5:
    buffer_load_dwordx4 v[120:123], v4, s[4:7], s63 offen offset:512 nt
    v_dot2c_f32_bf16 v80, v96, v16
    v_dot2c_f32_bf16 v81, v96, v17
    v_dot2c_f32_bf16 v82, v97, v16
    v_dot2c_f32_bf16 v83, v97, v17
    v_dot2c_f32_bf16 v84, v98, v16
    v_dot2c_f32_bf16 v85, v98, v17
    v_dot2c_f32_bf16 v86, v99, v16
    v_dot2c_f32_bf16 v87, v99, v17
    s_waitcnt vmcnt(5)
    s_waitcnt lgkmcnt(0)
    s_sub_u32 s36, s36, s64
    s_sub_i32 s36, s36, 428
    s_ashr_i32 s36, s36, 5
    s_add_i32 s67, s36, 4
    s_cmp_gt_i32 s67, 5
    s_cbranch_scc1 Li_6
    s_waitcnt vmcnt(4)
    s_cmp_gt_i32 s67, 4
    s_cbranch_scc1 Li_6
    s_waitcnt vmcnt(3)
    s_cmp_gt_i32 s67, 3
    s_cbranch_scc1 Li_6
    s_waitcnt vmcnt(2)
Li_6:
    buffer_load_dwordx4 v[124:127], v4, s[4:7], s63 offen offset:640 nt
    v_dot2c_f32_bf16 v80, v100, v18
    v_dot2c_f32_bf16 v81, v100, v19
    v_dot2c_f32_bf16 v82, v101, v18
    v_dot2c_f32_bf16 v83, v101, v19
    v_dot2c_f32_bf16 v84, v102, v18
    v_dot2c_f32_bf16 v85, v102, v19
    v_dot2c_f32_bf16 v86, v103, v18
    v_dot2c_f32_bf16 v87, v103, v19
    s_waitcnt vmcnt(5)
    s_cmp_gt_i32 s67, 5
    s_cbranch_scc1 Li_7
    s_waitcnt vmcnt(4)
    s_cmp_gt_i32 s67, 4
    s_cbranch_scc1 Li_7
    s_waitcnt vmcnt(3)
    s_cmp_gt_i32 s67, 3
    s_cbranch_scc1 Li_7
    s_waitcnt vmcnt(2)
Li_7:
    s_xor_b32 s63, s52, 4096
    buffer_load_dwordx4 v[48:51], v4, s[4:7], s63 offen offset:0 nt
    v_dot2c_f32_bf16 v80, v104, v20
    v_dot2c_f32_bf16 v81, v104, v21
    v_dot2c_f32_bf16 v82, v105, v20
    v_dot2c_f32_bf16 v83, v105, v21
    v_dot2c_f32_bf16 v84, v106, v20
    v_dot2c_f32_bf16 v85, v106, v21
    v_dot2c_f32_bf16 v86, v107, v20
    v_dot2c_f32_bf16 v87, v107, v21
    s_waitcnt vmcnt(5)
    s_memrealtime s[36:37]
    s_cmp_gt_i32 s67, 5
    s_cbranch_scc1 Li_8
    s_waitcnt vmcnt(4)
    s_cmp_gt_i32 s67, 4
    s_cbranch_scc1 Li_8
    s_waitcnt vmcnt(3)
    s_cmp_gt_i32 s67, 3
    s_cbranch_scc1 Li_8
    s_waitcnt vmcnt(2)
Li_8:
    buffer_load_dwordx4 v[52:55], v4, s[4:7], s63 offen offset:128 nt
    v_dot2c_f32_bf16 v80, v108, v22
    v_dot2c_f32_bf16 v81, v108, v23
    v_dot2c_f32_bf16 v82, v109, v22
    v_dot2c_f32_bf16 v83, v109, v23
    v_dot2c_f32_bf16 v84, v110, v22
    v_dot2c_f32_bf16 v85, v110, v23
    v_dot2c_f32_bf16 v86, v111, v22
    v_dot2c_f32_bf16 v87, v111, v23
    v_permlane32_swap_b32 v80, v84
    v_permlane32_swap_b32 v81, v85
    v_permlane32_swap_b32 v82, v86
    v_permlane32_swap_b32 v83, v87
    v_add_f32 v80, v80, v84
    v_add_f32 v81, v81, v85
    v_add_f32 v82, v82, v86
    v_add_f32 v83, v83, v87
    s_nop 0
    v_permlane16_swap_b32 v80, v82
    v_permlane16_swap_b32 v81, v83
    v_add_f32 v80, v80, v82
    v_add_f32 v81, v81, v83
    ds_write_b64 v24, v[80:81] offset:8448
    v_mov_b32 v8, 4
    v_mov_b32 v9, 1
    s_waitcnt lgkmcnt(0)
    s_mov_b64 exec, 1
    ds_add_u32 v8, v9
    s_mov_b64 exec, -1
    s_waitcnt vmcnt(5)
    s_waitcnt lgkmcnt(0)
    s_sub_u32 s36, s36, s64
    s_sub_i32 s36, s36, 511
    s_ashr_i32 s36, s36, 5
    s_add_i32 s67, s36, 4
    s_cmp_gt_i32 s67, 5
    s_cbranch_scc1 Li_9
    s_waitcnt vmcnt(4)
    s_cmp_gt_i32 s67, 4
    s_cbranch_scc1 Li_9
    s_waitcnt vmcnt(3)
    s_cmp_gt_i32 s67, 3
    s_cbranch_scc1 Li_9
    s_waitcnt vmcnt(2)
Li_9:
    buffer_load_dwordx4 v[56:59], v4, s[4:7], s63 offen offset:512 nt
    s_waitcnt vmcnt(5)
    s_cmp_gt_i32 s67, 5
    s_cbranch_scc1 Li_10
    s_waitcnt vmcnt(4)
    s_cmp_gt_i32 s67, 4
    s_cbranch_scc1 Li_10
    s_waitcnt vmcnt(3)
    s_cmp_gt_i32 s67, 3
    s_cbranch_scc1 Li_10
    s_waitcnt vmcnt(2)
Li_10:
    buffer_load_dwordx4 v[60:63], v4, s[4:7], s63 offen offset:640 nt
    s_waitcnt vmcnt(5)
    s_memrealtime s[36:37]
    s_cmp_gt_i32 s67, 5
    s_cbranch_scc1 Li_11
    s_waitcnt vmcnt(4)
    s_cmp_gt_i32 s67, 4
    s_cbranch_scc1 Li_11
    s_waitcnt vmcnt(3)
    s_cmp_gt_i32 s67, 3
    s_cbranch_scc1 Li_11
    s_waitcnt vmcnt(2)
Li_11:
    s_xor_b32 s63, s52, 4194304
    buffer_load_dwordx4 v[128:131], v4, s[4:7], s63 offen offset:0 nt
    s_waitcnt vmcnt(5)
    s_waitcnt lgkmcnt(0)
    s_sub_u32 s36, s36, s64
    s_sub_i32 s36, s36, 594
    s_ashr_i32 s36, s36, 5
    s_add_i32 s67, s36, 4
    s_cmp_gt_i32 s67, 5
    s_cbranch_scc1 Li_12
    s_waitcnt vmcnt(4)
    s_cmp_gt_i32 s67, 4
    s_cbranch_scc1 Li_12
    s_waitcnt vmcnt(3)
    s_cmp_gt_i32 s67, 3
    s_cbranch_scc1 Li_12
    s_waitcnt vmcnt(2)
Li_12:
    buffer_load_dwordx4 v[132:135], v4, s[4:7], s63 offen offset:128 nt
    s_waitcnt vmcnt(5)
    s_cmp_gt_i32 s67, 5
    s_cbranch_scc1 Li_13
    s_waitcnt vmcnt(4)
    s_cmp_gt_i32 s67, 4
    s_cbranch_scc1 Li_13
    s_waitcnt vmcnt(3)
    s_cmp_gt_i32 s67, 3
    s_cbranch_scc1 Li_13
    s_waitcnt vmcnt(2)
Li_13:
    buffer_load_dwordx4 v[136:139], v4, s[4:7], s63 offen offset:512 nt
    s_waitcnt vmcnt(5)
    s_memrealtime s[36:37]
    s_cmp_gt_i32 s67, 5
    s_cbranch_scc1 Li_14
    s_waitcnt vmcnt(4)
    s_cmp_gt_i32 s67, 4
    s_cbranch_scc1 Li_14
    s_waitcnt vmcnt(3)
    s_cmp_gt_i32 s67, 3
    s_cbranch_scc1 Li_14
    s_waitcnt vmcnt(2)
Li_14:
    buffer_load_dwordx4 v[140:143], v4, s[4:7], s63 offen offset:640 nt
    v_mov_b32 v8, 20
    v_mov_b32 v9, 1
    s_waitcnt lgkmcnt(0)
    s_mov_b64 exec, 1
    ds_add_u32 v8, v9
    s_mov_b64 exec, -1
    s_waitcnt vmcnt(5)
    s_waitcnt lgkmcnt(0)
    s_sub_u32 s36, s36, s64
    s_sub_i32 s36, s36, 677
    s_ashr_i32 s36, s36, 5
    s_add_i32 s67, s36, 4
    s_cmp_gt_i32 s67, 5
    s_cbranch_scc1 Li_15
    s_waitcnt vmcnt(4)
    s_cmp_gt_i32 s67, 4
    s_cbranch_scc1 Li_15
    s_waitcnt vmcnt(3)
    s_cmp_gt_i32 s67, 3
    s_cbranch_scc1 Li_15
    s_waitcnt vmcnt(2)
Li_15:
    s_xor_b32 s63, s52, 4198400
    buffer_load_dwordx4 v[144:147], v4, s[4:7], s63 offen offset:0 nt
    s_waitcnt vmcnt(5)
    s_cmp_gt_i32 s67, 5
    s_cbranch_scc1 Li_16
    s_waitcnt vmcnt(4)
    s_cmp_gt_i32 s67, 4
    s_cbranch_scc1 Li_16
    s_waitcnt vmcnt(3)
    s_cmp_gt_i32 s67, 3
    s_cbranch_scc1 Li_16
    s_waitcnt vmcnt(2)
Li_16:
    buffer_load_dwordx4 v[148:151], v4, s[4:7], s63 offen offset:128 nt
    s_waitcnt vmcnt(5)
    s_memrealtime s[36:37]
    s_cmp_gt_i32 s67, 5
    s_cbranch_scc1 Li_17
    s_waitcnt vmcnt(4)
    s_cmp_gt_i32 s67, 4
    s_cbranch_scc1 Li_17
    s_waitcnt vmcnt(3)
    s_cmp_gt_i32 s67, 3
    s_cbranch_scc1 Li_17
    s_waitcnt vmcnt(2)
Li_17:
    buffer_load_dwordx4 v[152:155], v4, s[4:7], s63 offen offset:512 nt
    s_waitcnt vmcnt(5)
    s_waitcnt lgkmcnt(0)
    s_sub_u32 s36, s36, s64
    s_sub_i32 s36, s36, 759
    s_ashr_i32 s36, s36, 5
    s_add_i32 s67, s36, 4
    s_cmp_gt_i32 s67, 5
    s_cbranch_scc1 Li_18
    s_waitcnt vmcnt(4)
    s_cmp_gt_i32 s67, 4
    s_cbranch_scc1 Li_18
    s_waitcnt vmcnt(3)
    s_cmp_gt_i32 s67, 3
    s_cbranch_scc1 Li_18
    s_waitcnt vmcnt(2)
Li_18:
    buffer_load_dwordx4 v[156:159], v4, s[4:7], s63 offen offset:640 nt
    s_waitcnt vmcnt(5)
    s_cmp_gt_i32 s67, 5
    s_cbranch_scc1 Li_19
    s_waitcnt vmcnt(4)
    s_cmp_gt_i32 s67, 4
    s_cbranch_scc1 Li_19
    s_waitcnt vmcnt(3)
    s_cmp_gt_i32 s67, 3
    s_cbranch_scc1 Li_19
    s_waitcnt vmcnt(2)
Li_19:
    s_xor_b32 s63, s52, 8388608
    buffer_load_dwordx4 v[96:99], v4, s[4:7], s63 offen offset:0 nt
    s_waitcnt vmcnt(5)
    s_memrealtime s[36:37]
    s_cmp_gt_i32 s67, 5
    s_cbranch_scc1 Li_20
    s_waitcnt vmcnt(4)
    s_cmp_gt_i32 s67, 4
    s_cbranch_scc1 Li_20
    s_waitcnt vmcnt(3)
    s_cmp_gt_i32 s67, 3
    s_cbranch_scc1 Li_20
    s_waitcnt vmcnt(2)
Li_20:
    buffer_load_dwordx4 v[100:103], v4, s[4:7], s63 offen offset:128 nt
    s_waitcnt vmcnt(5)
    s_waitcnt lgkmcnt(0)
    s_sub_u32 s36, s36, s64
    s_sub_i32 s36, s36, 842
    s_ashr_i32 s36, s36, 5
    s_add_i32 s67, s36, 4
    s_cmp_gt_i32 s67, 5
    s_cbranch_scc1 Li_21
    s_waitcnt vmcnt(4)
    s_cmp_gt_i32 s67, 4
    s_cbranch_scc1 Li_21
    s_waitcnt vmcnt(3)
    s_cmp_gt_i32 s67, 3
    s_cbranch_scc1 Li_21
    s_waitcnt vmcnt(2)
Li_21:
    buffer_load_dwordx4 v[104:107], v4, s[4:7], s63 offen offset:512 nt
    s_waitcnt vmcnt(5)
    s_cmp_gt_i32 s67, 5
    s_cbranch_scc1 Li_22
    s_waitcnt vmcnt(4)
    s_cmp_gt_i32 s67, 4
    s_cbranch_scc1 Li_22
    s_waitcnt vmcnt(3)
    s_cmp_gt_i32 s67, 3
    s_cbranch_scc1 Li_22
    s_waitcnt vmcnt(2)
Li_22:
    buffer_load_dwordx4 v[108:111], v4, s[4:7], s63 offen offset:640 nt
    v_mov_b32 v8, 8
    s_mov_b32 s60, 0
Lw_23:
    ds_read_b32 v9, v8
    s_waitcnt lgkmcnt(0)
    v_readfirstlane_b32 s53, v9
    s_cmp_ge_u32 s53, 1
    s_cbranch_scc1 Lwd_24
    s_add_u32 s60, s60, 1
    s_cmp_gt_u32 s60, 0x400000
    s_cbranch_scc1 Lwd_24
    s_sleep 1
    s_branch Lw_23
Lwd_24:
    v_and_b32 v8, 7, v0
    v_mul_u32_u24 v8, 272, v8
    v_bfe_u32 v9, v0, 3, 1
    v_lshl_add_u32 v8, v9, 6, v8
    v_lshrrev_b32 v9, 4, v0
    v_lshl_add_u32 v8, v9, 4, v8
    ds_read_b128 v[32:35], v8 offset:12544
    ds_read_b128 v[36:39], v8 offset:12672
    s_waitcnt lgkmcnt(0)
    v_mfma_f32_16x16x32_bf16 v[64:67], v[112:115], v[32:35], 0
    v_mfma_f32_16x16x32_bf16 v[16:19], v[120:123], v[32:35], 0
    v_mfma_f32_16x16x32_bf16 v[64:67], v[116:119], v[36:39], v[64:67]
    v_mfma_f32_16x16x32_bf16 v[16:19], v[124:127], v[36:39], v[16:19]
    s_nop 7
    v_permlane32_swap_b32 v64, v16
    v_permlane32_swap_b32 v65, v17
    v_permlane32_swap_b32 v66, v18
    v_permlane32_swap_b32 v67, v19
    v_add_f32_dpp v64, v16, v64 row_ror:8 row_mask:0xf bank_mask:0xf
    v_add_f32_dpp v65, v17, v65 row_ror:8 row_mask:0xf bank_mask:0xf
    v_add_f32_dpp v66, v18, v66 row_ror:8 row_mask:0xf bank_mask:0xf
    v_add_f32_dpp v67, v19, v67 row_ror:8 row_mask:0xf bank_mask:0xf
    s_waitcnt vmcnt(5)
    s_memrealtime s[36:37]
    s_cmp_gt_i32 s67, 5
    s_cbranch_scc1 Li_25
    s_waitcnt vmcnt(4)
    s_cmp_gt_i32 s67, 4
    s_cbranch_scc1 Li_25
    s_waitcnt vmcnt(3)
    s_cmp_gt_i32 s67, 3
    s_cbranch_scc1 Li_25
    s_waitcnt vmcnt(2)
Li_25:
    s_xor_b32 s63, s52, 8392704
    buffer_load_dwordx4 v[112:115], v4, s[4:7], s63 offen offset:0 nt
    v_mfma_f32_16x16x32_bf16 v[68:71], v[48:51], v[32:35], 0
    v_mfma_f32_16x16x32_bf16 v[16:19], v[56:59], v[32:35], 0
    v_mfma_f32_16x16x32_bf16 v[68:71], v[52:55], v[36:39], v[68:71]
    v_mfma_f32_16x16x32_bf16 v[16:19], v[60:63], v[36:39], v[16:19]
    s_nop 7
    v_permlane32_swap_b32 v68, v16
    v_permlane32_swap_b32 v69, v17
    v_permlane32_swap_b32 v70, v18
    v_permlane32_swap_b32 v71, v19
    v_add_f32_dpp v68, v16, v68 row_ror:8 row_mask:0xf bank_mask:0xf
    v_add_f32_dpp v69, v17, v69 row_ror:8 row_mask:0xf bank_mask:0xf
    v_add_f32_dpp v70, v18, v70 row_ror:8 row_mask:0xf bank_mask:0xf
    v_add_f32_dpp v71, v19, v71 row_ror:8 row_mask:0xf bank_mask:0xf
    v_mfma_f32_16x16x32_bf16 v[72:75], v[128:131], v[32:35], 0
    v_mfma_f32_16x16x32_bf16 v[16:19], v[136:139], v[32:35], 0
    v_mfma_f32_16x16x32_bf16 v[72:75], v[132:135], v[36:39], v[72:75]
    v_mfma_f32_16x16x32_bf16 v[16:19], v[140:143], v[36:39], v[16:19]
    s_nop 7
    v_permlane32_swap_b32 v72, v16
    v_permlane32_swap_b32 v73, v17
    v_permlane32_swap_b32 v74, v18
    v_permlane32_swap_b32 v75, v19
    v_add_f32_dpp v72, v16, v72 row_ror:8 row_mask:0xf bank_mask:0xf
    v_add_f32_dpp v73, v17, v73 row_ror:8 row_mask:0xf bank_mask:0xf
    v_add_f32_dpp v74, v18, v74 row_ror:8 row_mask:0xf bank_mask:0xf
    v_add_f32_dpp v75, v19, v75 row_ror:8 row_mask:0xf bank_mask:0xf
    s_waitcnt vmcnt(5)
    s_waitcnt lgkmcnt(0)
    s_sub_u32 s36, s36, s64
    s_sub_i32 s36, s36, 925
    s_ashr_i32 s36, s36, 5
    s_add_i32 s67, s36, 4
    s_cmp_gt_i32 s67, 5
    s_cbranch_scc1 Li_26
    s_waitcnt vmcnt(4)
    s_cmp_gt_i32 s67, 4
    s_cbranch_scc1 Li_26
    s_waitcnt vmcnt(3)
    s_cmp_gt_i32 s67, 3
    s_cbranch_scc1 Li_26
    s_waitcnt vmcnt(2)
Li_26:
    buffer_load_dwordx4 v[116:119], v4, s[4:7], s63 offen offset:128 nt
    v_mfma_f32_16x16x32_bf16 v[76:79], v[144:147], v[32:35], 0
    v_mfma_f32_16x16x32_bf16 v[16:19], v[152:155], v[32:35], 0
    v_mfma_f32_16x16x32_bf16 v[76:79], v[148:151], v[36:39], v[76:79]
    v_mfma_f32_16x16x32_bf16 v[16:19], v[156:159], v[36:39], v[16:19]
    s_nop 7
    v_permlane32_swap_b32 v76, v16
    v_permlane32_swap_b32 v77, v17
    v_permlane32_swap_b32 v78, v18
    v_permlane32_swap_b32 v79, v19
    v_add_f32_dpp v76, v16, v76 row_ror:8 row_mask:0xf bank_mask:0xf
    v_add_f32_dpp v77, v17, v77 row_ror:8 row_mask:0xf bank_mask:0xf
    v_add_f32_dpp v78, v18, v78 row_ror:8 row_mask:0xf bank_mask:0xf
    v_add_f32_dpp v79, v19, v79 row_ror:8 row_mask:0xf bank_mask:0xf
    s_waitcnt vmcnt(5)
    s_cmp_gt_i32 s67, 5
    s_cbranch_scc1 Li_27
    s_waitcnt vmcnt(4)
    s_cmp_gt_i32 s67, 4
    s_cbranch_scc1 Li_27
    s_waitcnt vmcnt(3)
    s_cmp_gt_i32 s67, 3
    s_cbranch_scc1 Li_27
    s_waitcnt vmcnt(2)
Li_27:
    buffer_load_dwordx4 v[120:123], v4, s[4:7], s63 offen offset:512 nt
    s_waitcnt vmcnt(5)
    s_memrealtime s[36:37]
    s_cmp_gt_i32 s67, 5
    s_cbranch_scc1 Li_28
    s_waitcnt vmcnt(4)
    s_cmp_gt_i32 s67, 4
    s_cbranch_scc1 Li_28
    s_waitcnt vmcnt(3)
    s_cmp_gt_i32 s67, 3
    s_cbranch_scc1 Li_28
    s_waitcnt vmcnt(2)
Li_28:
    buffer_load_dwordx4 v[124:127], v4, s[4:7], s63 offen offset:640 nt
    s_waitcnt vmcnt(5)
    s_waitcnt lgkmcnt(0)
    s_sub_u32 s36, s36, s64
    s_sub_i32 s36, s36, 1008
    s_ashr_i32 s36, s36, 5
    s_add_i32 s67, s36, 4
    s_cmp_gt_i32 s67, 5
    s_cbranch_scc1 Li_29
    s_waitcnt vmcnt(4)
    s_cmp_gt_i32 s67, 4
    s_cbranch_scc1 Li_29
    s_waitcnt vmcnt(3)
    s_cmp_gt_i32 s67, 3
    s_cbranch_scc1 Li_29
    s_waitcnt vmcnt(2)
Li_29:
    s_xor_b32 s63, s52, 12582912
    buffer_load_dwordx4 v[48:51], v4, s[4:7], s63 offen offset:0 nt
    s_waitcnt vmcnt(5)
    s_cmp_gt_i32 s67, 5
    s_cbranch_scc1 Li_30
    s_waitcnt vmcnt(4)
    s_cmp_gt_i32 s67, 4
    s_cbranch_scc1 Li_30
    s_waitcnt vmcnt(3)
    s_cmp_gt_i32 s67, 3
    s_cbranch_scc1 Li_30
    s_waitcnt vmcnt(2)
Li_30:
    buffer_load_dwordx4 v[52:55], v4, s[4:7], s63 offen offset:128 nt
    v_mfma_f32_16x16x32_bf16 v[80:83], v[96:99], v[32:35], 0
    v_mfma_f32_16x16x32_bf16 v[16:19], v[104:107], v[32:35], 0
    v_mfma_f32_16x16x32_bf16 v[80:83], v[100:103], v[36:39], v[80:83]
    v_mfma_f32_16x16x32_bf16 v[16:19], v[108:111], v[36:39], v[16:19]
    s_nop 7
    v_permlane32_swap_b32 v80, v16
    v_permlane32_swap_b32 v81, v17
    v_permlane32_swap_b32 v82, v18
    v_permlane32_swap_b32 v83, v19
    v_add_f32_dpp v80, v16, v80 row_ror:8 row_mask:0xf bank_mask:0xf
    v_add_f32_dpp v81, v17, v81 row_ror:8 row_mask:0xf bank_mask:0xf
    v_add_f32_dpp v82, v18, v82 row_ror:8 row_mask:0xf bank_mask:0xf
    v_add_f32_dpp v83, v19, v83 row_ror:8 row_mask:0xf bank_mask:0xf
    s_waitcnt vmcnt(5)
    s_memrealtime s[36:37]
    s_cmp_gt_i32 s67, 5
    s_cbranch_scc1 Li_31
    s_waitcnt vmcnt(4)
    s_cmp_gt_i32 s67, 4
    s_cbranch_scc1 Li_31
    s_waitcnt vmcnt(3)
    s_cmp_gt_i32 s67, 3
    s_cbranch_scc1 Li_31
    s_waitcnt vmcnt(2)
Li_31:
    buffer_load_dwordx4 v[56:59], v4, s[4:7], s63 offen offset:512 nt
    s_waitcnt vmcnt(5)
    s_waitcnt lgkmcnt(0)
    s_sub_u32 s36, s36, s64
    s_sub_i32 s36, s36, 1091
    s_ashr_i32 s36, s36, 5
    s_add_i32 s67, s36, 4
    s_cmp_gt_i32 s67, 5
    s_cbranch_scc1 Li_32
    s_waitcnt vmcnt(4)
    s_cmp_gt_i32 s67, 4
    s_cbranch_scc1 Li_32
    s_waitcnt vmcnt(3)
    s_cmp_gt_i32 s67, 3
    s_cbranch_scc1 Li_32
    s_waitcnt vmcnt(2)
Li_32:
    buffer_load_dwordx4 v[60:63], v4, s[4:7], s63 offen offset:640 nt
    s_waitcnt vmcnt(5)
    s_cmp_gt_i32 s67, 5
    s_cbranch_scc1 Li_33
    s_waitcnt vmcnt(4)
    s_cmp_gt_i32 s67, 4
    s_cbranch_scc1 Li_33
    s_waitcnt vmcnt(3)
    s_cmp_gt_i32 s67, 3
    s_cbranch_scc1 Li_33
    s_waitcnt vmcnt(2)
Li_33:
    s_xor_b32 s63, s52, 12587008
    buffer_load_dwordx4 v[96:99], v4, s[4:7], s63 offen offset:0 nt
    s_waitcnt vmcnt(5)
    s_memrealtime s[36:37]
    s_cmp_gt_i32 s67, 5
    s_cbranch_scc1 Li_34
    s_waitcnt vmcnt(4)
    s_cmp_gt_i32 s67, 4
    s_cbranch_scc1 Li_34
    s_waitcnt vmcnt(3)
    s_cmp_gt_i32 s67, 3
    s_cbranch_scc1 Li_34
    s_waitcnt vmcnt(2)
Li_34:
    buffer_load_dwordx4 v[100:103], v4, s[4:7], s63 offen offset:128 nt
    v_mfma_f32_16x16x32_bf16 v[84:87], v[112:115], v[32:35], 0
    v_mfma_f32_16x16x32_bf16 v[16:19], v[120:123], v[32:35], 0
    v_mfma_f32_16x16x32_bf16 v[84:87], v[116:119], v[36:39], v[84:87]
    v_mfma_f32_16x16x32_bf16 v[16:19], v[124:127], v[36:39], v[16:19]
    s_nop 7
    v_permlane32_swap_b32 v84, v16
    v_permlane32_swap_b32 v85, v17
    v_permlane32_swap_b32 v86, v18
    v_permlane32_swap_b32 v87, v19
    v_add_f32_dpp v84, v16, v84 row_ror:8 row_mask:0xf bank_mask:0xf
    v_add_f32_dpp v85, v17, v85 row_ror:8 row_mask:0xf bank_mask:0xf
    v_add_f32_dpp v86, v18, v86 row_ror:8 row_mask:0xf bank_mask:0xf
    v_add_f32_dpp v87, v19, v87 row_ror:8 row_mask:0xf bank_mask:0xf
    s_waitcnt vmcnt(5)
    s_waitcnt lgkmcnt(0)
    s_sub_u32 s36, s36, s64
    s_sub_i32 s36, s36, 1173
    s_ashr_i32 s36, s36, 5
    s_add_i32 s67, s36, 4
    s_cmp_gt_i32 s67, 5
    s_cbranch_scc1 Li_35
    s_waitcnt vmcnt(4)
    s_cmp_gt_i32 s67, 4
    s_cbranch_scc1 Li_35
    s_waitcnt vmcnt(3)
    s_cmp_gt_i32 s67, 3
    s_cbranch_scc1 Li_35
    s_waitcnt vmcnt(2)
Li_35:
    buffer_load_dwordx4 v[104:107], v4, s[4:7], s63 offen offset:512 nt
    s_waitcnt vmcnt(5)
    s_cmp_gt_i32 s67, 5
    s_cbranch_scc1 Li_36
    s_waitcnt vmcnt(4)
    s_cmp_gt_i32 s67, 4
    s_cbranch_scc1 Li_36
    s_waitcnt vmcnt(3)
    s_cmp_gt_i32 s67, 3
    s_cbranch_scc1 Li_36
    s_waitcnt vmcnt(2)
Li_36:
    buffer_load_dwordx4 v[108:111], v4, s[4:7], s63 offen offset:640 nt
    s_waitcnt vmcnt(5)
    s_memrealtime s[36:37]
    s_cmp_gt_i32 s67, 5
    s_cbranch_scc1 Li_37
    s_waitcnt vmcnt(4)
    s_cmp_gt_i32 s67, 4
    s_cbranch_scc1 Li_37
    s_waitcnt vmcnt(3)
    s_cmp_gt_i32 s67, 3
    s_cbranch_scc1 Li_37
    s_waitcnt vmcnt(2)
Li_37:
    s_xor_b32 s63, s75, 0
    buffer_load_dwordx4 v[128:131], v5, s[8:11], s63 offen nt
    s_waitcnt vmcnt(5)
    s_waitcnt lgkmcnt(0)
    s_sub_u32 s36, s36, s64
    s_sub_i32 s36, s36, 1256
    s_ashr_i32 s36, s36, 5
    s_add_i32 s67, s36, 4
    s_cmp_gt_i32 s67, 5
    s_cbranch_scc1 Li_38
    s_waitcnt vmcnt(4)
    s_cmp_gt_i32 s67, 4
    s_cbranch_scc1 Li_38
    s_waitcnt vmcnt(3)
    s_cmp_gt_i32 s67, 3
    s_cbranch_scc1 Li_38
    s_waitcnt vmcnt(2)
Li_38:
    s_xor_b32 s63, s75, 1024
    buffer_load_dwordx4 v[132:135], v5, s[8:11], s63 offen nt
    v_mfma_f32_16x16x32_bf16 v[88:91], v[48:51], v[32:35], 0
    v_mfma_f32_16x16x32_bf16 v[16:19], v[56:59], v[32:35], 0
    v_mfma_f32_16x16x32_bf16 v[88:91], v[52:55], v[36:39], v[88:91]
    v_mfma_f32_16x16x32_bf16 v[16:19], v[60:63], v[36:39], v[16:19]
    s_nop 7
    v_permlane32_swap_b32 v88, v16
    v_permlane32_swap_b32 v89, v17
    v_permlane32_swap_b32 v90, v18
    v_permlane32_swap_b32 v91, v19
    v_add_f32_dpp v88, v16, v88 row_ror:8 row_mask:0xf bank_mask:0xf
    v_add_f32_dpp v89, v17, v89 row_ror:8 row_mask:0xf bank_mask:0xf
    v_add_f32_dpp v90, v18, v90 row_ror:8 row_mask:0xf bank_mask:0xf
    v_add_f32_dpp v91, v19, v91 row_ror:8 row_mask:0xf bank_mask:0xf
    s_waitcnt vmcnt(5)
    s_cmp_gt_i32 s67, 5
    s_cbranch_scc1 Li_39
    s_waitcnt vmcnt(4)
    s_cmp_gt_i32 s67, 4
    s_cbranch_scc1 Li_39
    s_waitcnt vmcnt(3)
    s_cmp_gt_i32 s67, 3
    s_cbranch_scc1 Li_39
    s_waitcnt vmcnt(2)
Li_39:
    s_xor_b32 s63, s75, 2048
    buffer_load_dwordx4 v[136:139], v5, s[8:11], s63 offen nt
    s_waitcnt vmcnt(5)
    s_memrealtime s[36:37]
    s_cmp_gt_i32 s67, 5
    s_cbranch_scc1 Li_40
    s_waitcnt vmcnt(4)
    s_cmp_gt_i32 s67, 4
    s_cbranch_scc1 Li_40
    s_waitcnt vmcnt(3)
    s_cmp_gt_i32 s67, 3
    s_cbranch_scc1 Li_40
    s_waitcnt vmcnt(2)
Li_40:
    s_xor_b32 s63, s75, 3072
    buffer_load_dwordx4 v[140:143], v5, s[8:11], s63 offen nt
    s_waitcnt vmcnt(5)
    s_waitcnt lgkmcnt(0)
    s_sub_u32 s36, s36, s64
    s_sub_i32 s36, s36, 1339
    s_ashr_i32 s36, s36, 5
    s_add_i32 s67, s36, 4
    s_cmp_gt_i32 s67, 5
    s_cbranch_scc1 Li_41
    s_waitcnt vmcnt(4)
    s_cmp_gt_i32 s67, 4
    s_cbranch_scc1 Li_41
    s_waitcnt vmcnt(3)
    s_cmp_gt_i32 s67, 3
    s_cbranch_scc1 Li_41
    s_waitcnt vmcnt(2)
Li_41:
    s_xor_b32 s63, s75, 4096
    buffer_load_dwordx4 v[144:147], v5, s[8:11], s63 offen nt
    s_waitcnt vmcnt(5)
    s_cmp_gt_i32 s67, 5
    s_cbranch_scc1 Li_42
    s_waitcnt vmcnt(4)
    s_cmp_gt_i32 s67, 4
    s_cbranch_scc1 Li_42
    s_waitcnt vmcnt(3)
    s_cmp_gt_i32 s67, 3
    s_cbranch_scc1 Li_42
    s_waitcnt vmcnt(2)
Li_42:
    s_xor_b32 s63, s75, 5120
    buffer_load_dwordx4 v[148:151], v5, s[8:11], s63 offen nt
    v_mfma_f32_16x16x32_bf16 v[92:95], v[96:99], v[32:35], 0
    v_mfma_f32_16x16x32_bf16 v[16:19], v[104:107], v[32:35], 0
    v_mfma_f32_16x16x32_bf16 v[92:95], v[100:103], v[36:39], v[92:95]
    v_mfma_f32_16x16x32_bf16 v[16:19], v[108:111], v[36:39], v[16:19]
    s_nop 7
    v_permlane32_swap_b32 v92, v16
    v_permlane32_swap_b32 v93, v17
    v_permlane32_swap_b32 v94, v18
    v_permlane32_swap_b32 v95, v19
    v_add_f32_dpp v92, v16, v92 row_ror:8 row_mask:0xf bank_mask:0xf
    v_add_f32_dpp v93, v17, v93 row_ror:8 row_mask:0xf bank_mask:0xf
    v_add_f32_dpp v94, v18, v94 row_ror:8 row_mask:0xf bank_mask:0xf
    v_add_f32_dpp v95, v19, v95 row_ror:8 row_mask:0xf bank_mask:0xf
    v_max3_f32 v40, v64, v65, v66
    v_max3_f32 v10, v67, v68, v69
    v_max3_f32 v40, v40, v70, v71
    v_max3_f32 v10, v10, v72, v73
    v_max3_f32 v40, v40, v74, v75
    v_max3_f32 v10, v10, v76, v77
    v_max3_f32 v40, v40, v78, v79
    v_max3_f32 v10, v10, v80, v81
    v_max3_f32 v40, v40, v82, v83
    v_max3_f32 v10, v10, v84, v85
    v_max3_f32 v40, v40, v86, v87
    v_max3_f32 v10, v10, v88, v89
    v_max3_f32 v40, v40, v90, v91
    v_max3_f32 v10, v10, v92, v93
    v_max3_f32 v40, v40, v94, v95
    v_max_f32 v40, v40, v10
    v_mov_b32 v10, v40
    s_nop 1
    v_permlane16_swap_b32 v40, v10
    v_max_f32 v40, v40, v10
    v_mov_b32 v10, v40
    s_nop 1
    v_permlane32_swap_b32 v40, v10
    v_max_f32 v40, v40, v10
    v_mul_f32 v40, s59, v40
    s_waitcnt vmcnt(5)
    s_memrealtime s[36:37]
    s_cmp_gt_i32 s67, 5
    s_cbranch_scc1 Li_43
    s_waitcnt vmcnt(4)
    s_cmp_gt_i32 s67, 4
    s_cbranch_scc1 Li_43
    s_waitcnt vmcnt(3)
    s_cmp_gt_i32 s67, 3
    s_cbranch_scc1 Li_43
    s_waitcnt vmcnt(2)
Li_43:
    s_xor_b32 s63, s75, 6144
    buffer_load_dwordx4 v[152:155], v5, s[8:11], s63 offen nt
    v_fma_f32 v64, v64, s59, -v40
    v_fma_f32 v65, v65, s59, -v40
    v_fma_f32 v66, v66, s59, -v40
    v_fma_f32 v67, v67, s59, -v40
    v_fma_f32 v68, v68, s59, -v40
    v_fma_f32 v69, v69, s59, -v40
    v_fma_f32 v70, v70, s59, -v40
    v_fma_f32 v71, v71, s59, -v40
    v_exp_f32 v64, v64
    v_exp_f32 v65, v65
    v_exp_f32 v66, v66
    v_exp_f32 v67, v67
    v_exp_f32 v68, v68
    v_exp_f32 v69, v69
    v_exp_f32 v70, v70
    v_exp_f32 v71, v71
    v_cvt_pk_bf16_f32 v48, v64, v65
    v_cvt_pk_bf16_f32 v49, v66, v67
    v_cvt_pk_bf16_f32 v50, v68, v69
    v_cvt_pk_bf16_f32 v51, v70, v71
    v_add_f32 v64, v64, v65
    v_add_f32 v66, v66, v67
    v_add_f32 v68, v68, v69
    v_add_f32 v70, v70, v71
    v_add_f32 v64, v64, v66
    v_add_f32 v68, v68, v70
    v_add_f32 v64, v64, v68
    v_fma_f32 v72, v72, s59, -v40
    v_fma_f32 v73, v73, s59, -v40
    v_fma_f32 v74, v74, s59, -v40
    v_fma_f32 v75, v75, s59, -v40
    v_fma_f32 v76, v76, s59, -v40
    v_fma_f32 v77, v77, s59, -v40
    v_fma_f32 v78, v78, s59, -v40
    v_fma_f32 v79, v79, s59, -v40
    v_exp_f32 v72, v72
    v_exp_f32 v73, v73
    v_exp_f32 v74, v74
    v_exp_f32 v75, v75
    v_exp_f32 v76, v76
    v_exp_f32 v77, v77
    v_exp_f32 v78, v78
    v_exp_f32 v79, v79
    v_cvt_pk_bf16_f32 v52, v72, v73
    v_cvt_pk_bf16_f32 v53, v74, v75
    v_cvt_pk_bf16_f32 v54, v76, v77
    v_cvt_pk_bf16_f32 v55, v78, v79
    v_add_f32 v72, v72, v73
    v_add_f32 v74, v74, v75
    v_add_f32 v76, v76, v77
    v_add_f32 v78, v78, v79
    v_add_f32 v72, v72, v74
    v_add_f32 v76, v76, v78
    v_add_f32 v72, v72, v76
    s_waitcnt vmcnt(5)
    s_waitcnt lgkmcnt(0)
    s_sub_u32 s36, s36, s64
    s_sub_i32 s36, s36, 1422
    s_ashr_i32 s36, s36, 5
    s_add_i32 s67, s36, 4
    s_cmp_gt_i32 s67, 5
    s_cbranch_scc1 Li_44
    s_waitcnt vmcnt(4)
    s_cmp_gt_i32 s67, 4
    s_cbranch_scc1 Li_44
    s_waitcnt vmcnt(3)
    s_cmp_gt_i32 s67, 3
    s_cbranch_scc1 Li_44
    s_waitcnt vmcnt(2)
Li_44:
    s_xor_b32 s63, s75, 7168
    buffer_load_dwordx4 v[156:159], v5, s[8:11], s63 offen nt
    v_fma_f32 v80, v80, s59, -v40
    v_fma_f32 v81, v81, s59, -v40
    v_fma_f32 v82, v82, s59, -v40
    v_fma_f32 v83, v83, s59, -v40
    v_fma_f32 v84, v84, s59, -v40
    v_fma_f32 v85, v85, s59, -v40
    v_fma_f32 v86, v86, s59, -v40
    v_fma_f32 v87, v87, s59, -v40
    v_exp_f32 v80, v80
    v_exp_f32 v81, v81
    v_exp_f32 v82, v82
    v_exp_f32 v83, v83
    v_exp_f32 v84, v84
    v_exp_f32 v85, v85
    v_exp_f32 v86, v86
    v_exp_f32 v87, v87
    v_cvt_pk_bf16_f32 v56, v80, v81
    v_cvt_pk_bf16_f32 v57, v82, v83
    v_cvt_pk_bf16_f32 v58, v84, v85
    v_cvt_pk_bf16_f32 v59, v86, v87
    v_add_f32 v80, v80, v81
    v_add_f32 v82, v82, v83
    v_add_f32 v84, v84, v85
    v_add_f32 v86, v86, v87
    v_add_f32 v80, v80, v82
    v_add_f32 v84, v84, v86
    v_add_f32 v80, v80, v84
    v_fma_f32 v88, v88, s59, -v40
    v_fma_f32 v89, v89, s59, -v40
    v_fma_f32 v90, v90, s59, -v40
    v_fma_f32 v91, v91, s59, -v40
    v_fma_f32 v92, v92, s59, -v40
    v_fma_f32 v93, v93, s59, -v40
    v_fma_f32 v94, v94, s59, -v40
    v_fma_f32 v95, v95, s59, -v40
    v_exp_f32 v88, v88
    v_exp_f32 v89, v89
    v_exp_f32 v90, v90
    v_exp_f32 v91, v91
    v_exp_f32 v92, v92
    v_exp_f32 v93, v93
    v_exp_f32 v94, v94
    v_exp_f32 v95, v95
    v_cvt_pk_bf16_f32 v60, v88, v89
    v_cvt_pk_bf16_f32 v61, v90, v91
    v_cvt_pk_bf16_f32 v62, v92, v93
    v_cvt_pk_bf16_f32 v63, v94, v95
    v_add_f32 v88, v88, v89
    v_add_f32 v90, v90, v91
    v_add_f32 v92, v92, v93
    v_add_f32 v94, v94, v95
    v_add_f32 v88, v88, v90
    v_add_f32 v92, v92, v94
    v_add_f32 v88, v88, v92
    s_waitcnt vmcnt(5)
    v_add_f32 v64, v64, v72
    v_add_f32 v80, v80, v88
    v_add_f32 v41, v64, v80
    v_mov_b32 v10, v41
    s_nop 1
    v_permlane16_swap_b32 v41, v10
    v_add_f32 v41, v41, v10
    v_mov_b32 v10, v41
    s_nop 1
    v_permlane32_swap_b32 v41, v10
    v_add_f32 v41, v41, v10
    s_lshl_b32 s53, s3, 6
    v_lshl_add_u32 v10, v0, 3, s53
    s_mov_b64 exec, 0xff
    ds_write_b64 v10, v[40:41] offset:14720
    s_mov_b64 exec, -1
    v_mov_b32 v8, 12
    v_mov_b32 v9, 1
    s_waitcnt lgkmcnt(0)
    s_mov_b64 exec, 1
    ds_add_u32 v8, v9
    s_mov_b64 exec, -1
    v_perm_b32 v64, v132, v128, s57
    v_perm_b32 v68, v132, v128, s58
    v_perm_b32 v72, v133, v129, s57
    v_perm_b32 v76, v133, v129, s58
    v_perm_b32 v80, v134, v130, s57
    v_perm_b32 v84, v134, v130, s58
    v_perm_b32 v88, v135, v131, s57
    v_perm_b32 v92, v135, v131, s58
    s_cmp_gt_i32 s67, 5
    s_cbranch_scc1 Li_45
    s_waitcnt vmcnt(4)
    s_cmp_gt_i32 s67, 4
    s_cbranch_scc1 Li_45
    s_waitcnt vmcnt(3)
    s_cmp_gt_i32 s67, 3
    s_cbranch_scc1 Li_45
    s_waitcnt vmcnt(2)
Li_45:
    s_xor_b32 s63, s75, 4194304
    buffer_load_dwordx4 v[128:131], v5, s[8:11], s63 offen nt
    s_waitcnt vmcnt(5)
    s_memrealtime s[36:37]
    s_cmp_gt_i32 s67, 5
    s_cbranch_scc1 Li_46
    s_waitcnt vmcnt(4)
    s_cmp_gt_i32 s67, 4
    s_cbranch_scc1 Li_46
    s_waitcnt vmcnt(3)
    s_cmp_gt_i32 s67, 3
    s_cbranch_scc1 Li_46
    s_waitcnt vmcnt(2)
Li_46:
    s_xor_b32 s63, s75, 4195328
    buffer_load_dwordx4 v[132:135], v5, s[8:11], s63 offen nt
    v_perm_b32 v65, v140, v136, s57
    v_perm_b32 v69, v140, v136, s58
    v_perm_b32 v73, v141, v137, s57
    v_perm_b32 v77, v141, v137, s58
    v_perm_b32 v81, v142, v138, s57
    v_perm_b32 v85, v142, v138, s58
    v_perm_b32 v89, v143, v139, s57
    v_perm_b32 v93, v143, v139, s58
    s_waitcnt vmcnt(5)
    s_waitcnt lgkmcnt(0)
    s_sub_u32 s36, s36, s64
    s_sub_i32 s36, s36, 1505
    s_ashr_i32 s36, s36, 5
    s_add_i32 s67, s36, 4
    s_cmp_gt_i32 s67, 5
    s_cbranch_scc1 Li_47
    s_waitcnt vmcnt(4)
    s_cmp_gt_i32 s67, 4
    s_cbranch_scc1 Li_47
    s_waitcnt vmcnt(3)
    s_cmp_gt_i32 s67, 3
    s_cbranch_scc1 Li_47
    s_waitcnt vmcnt(2)
Li_47:
    s_xor_b32 s63, s75, 4196352
    buffer_load_dwordx4 v[136:139], v5, s[8:11], s63 offen nt
    s_waitcnt vmcnt(5)
    s_cmp_gt_i32 s67, 5
    s_cbranch_scc1 Li_48
    s_waitcnt vmcnt(4)
    s_cmp_gt_i32 s67, 4
    s_cbranch_scc1 Li_48
    s_waitcnt vmcnt(3)
    s_cmp_gt_i32 s67, 3
    s_cbranch_scc1 Li_48
    s_waitcnt vmcnt(2)
Li_48:
    s_xor_b32 s63, s75, 4197376
    buffer_load_dwordx4 v[140:143], v5, s[8:11], s63 offen nt
    v_perm_b32 v66, v148, v144, s57
    v_perm_b32 v70, v148, v144, s58
    v_perm_b32 v74, v149, v145, s57
    v_perm_b32 v78, v149, v145, s58
    v_perm_b32 v82, v150, v146, s57
    v_perm_b32 v86, v150, v146, s58
    v_perm_b32 v90, v151, v147, s57
    v_perm_b32 v94, v151, v147, s58
    s_waitcnt vmcnt(5)
    s_memrealtime s[36:37]
    s_cmp_gt_i32 s67, 5
    s_cbranch_scc1 Li_49
    s_waitcnt vmcnt(4)
    s_cmp_gt_i32 s67, 4
    s_cbranch_scc1 Li_49
    s_waitcnt vmcnt(3)
    s_cmp_gt_i32 s67, 3
    s_cbranch_scc1 Li_49
    s_waitcnt vmcnt(2)
Li_49:
    s_xor_b32 s63, s75, 4198400
    buffer_load_dwordx4 v[144:147], v5, s[8:11], s63 offen nt
    s_waitcnt vmcnt(5)
    s_waitcnt lgkmcnt(0)
    s_sub_u32 s36, s36, s64
    s_sub_i32 s36, s36, 1587
    s_ashr_i32 s36, s36, 5
    s_add_i32 s67, s36, 4
    s_cmp_gt_i32 s67, 5
    s_cbranch_scc1 Li_50
    s_waitcnt vmcnt(4)
    s_cmp_gt_i32 s67, 4
    s_cbranch_scc1 Li_50
    s_waitcnt vmcnt(3)
    s_cmp_gt_i32 s67, 3
    s_cbranch_scc1 Li_50
    s_waitcnt vmcnt(2)
Li_50:
    s_xor_b32 s63, s75, 4199424
    buffer_load_dwordx4 v[148:151], v5, s[8:11], s63 offen nt
    v_perm_b32 v67, v156, v152, s57
    v_perm_b32 v71, v156, v152, s58
    v_perm_b32 v75, v157, v153, s57
    v_perm_b32 v79, v157, v153, s58
    v_perm_b32 v83, v158, v154, s57
    v_perm_b32 v87, v158, v154, s58
    v_perm_b32 v91, v159, v155, s57
    v_perm_b32 v95, v159, v155, s58
    v_mfma_f32_16x16x32_bf16 v[96:99], v[64:67], v[48:51], 0
    v_mfma_f32_16x16x32_bf16 v[100:103], v[68:71], v[48:51], 0
    v_mfma_f32_16x16x32_bf16 v[104:107], v[72:75], v[48:51], 0
    v_mfma_f32_16x16x32_bf16 v[108:111], v[76:79], v[48:51], 0
    v_mfma_f32_16x16x32_bf16 v[112:115], v[80:83], v[48:51], 0
    v_mfma_f32_16x16x32_bf16 v[116:119], v[84:87], v[48:51], 0
    v_mfma_f32_16x16x32_bf16 v[120:123], v[88:91], v[48:51], 0
    v_mfma_f32_16x16x32_bf16 v[124:127], v[92:95], v[48:51], 0
    s_waitcnt vmcnt(5)
    s_cmp_gt_i32 s67, 5
    s_cbranch_scc1 Li_51
    s_waitcnt vmcnt(4)
    s_cmp_gt_i32 s67, 4
    s_cbranch_scc1 Li_51
    s_waitcnt vmcnt(3)
    s_cmp_gt_i32 s67, 3
    s_cbranch_scc1 Li_51
    s_waitcnt vmcnt(2)
Li_51:
    s_xor_b32 s63, s75, 4200448
    buffer_load_dwordx4 v[152:155], v5, s[8:11], s63 offen nt
    s_waitcnt vmcnt(5)
    s_memrealtime s[36:37]
    s_cmp_gt_i32 s67, 5
    s_cbranch_scc1 Li_52
    s_waitcnt vmcnt(4)
    s_cmp_gt_i32 s67, 4
    s_cbranch_scc1 Li_52
    s_waitcnt vmcnt(3)
    s_cmp_gt_i32 s67, 3
    s_cbranch_scc1 Li_52
    s_waitcnt vmcnt(2)
Li_52:
    s_xor_b32 s63, s75, 4201472
    buffer_load_dwordx4 v[156:159], v5, s[8:11], s63 offen nt
    v_perm_b32 v64, v132, v128, s57
    v_perm_b32 v68, v132, v128, s58
    v_perm_b32 v72, v133, v129, s57
    v_perm_b32 v76, v133, v129, s58
    v_perm_b32 v80, v134, v130, s57
    v_perm_b32 v84, v134, v130, s58
    v_perm_b32 v88, v135, v131, s57
    v_perm_b32 v92, v135, v131, s58
    s_waitcnt vmcnt(5)
    s_waitcnt lgkmcnt(0)
    s_sub_u32 s36, s36, s64
    s_sub_i32 s36, s36, 1670
    s_ashr_i32 s36, s36, 5
    s_add_i32 s67, s36, 4
    s_cmp_gt_i32 s67, 5
    s_cbranch_scc1 Li_53
    s_waitcnt vmcnt(4)
    s_cmp_gt_i32 s67, 4
    s_cbranch_scc1 Li_53
    s_waitcnt vmcnt(3)
    s_cmp_gt_i32 s67, 3
    s_cbranch_scc1 Li_53
    s_waitcnt vmcnt(2)
Li_53:
    s_xor_b32 s63, s75, 8388608
    buffer_load_dwordx4 v[128:131], v5, s[8:11], s63 offen nt
    v_lshrrev_b32 v9, 4, v0
    v_and_b32 v10, 7, v0
    v_mul_u32_u24 v8, 528, v10
    v_lshl_add_u32 v8, v9, 4, v8
    s_mul_i32 s53, s3, 4224
    v_add_u32 v32, s53, v8
    s_mul_i32 s53, s3, 528
    v_lshl_add_u32 v33, v0, 3, s53
    s_lshl_b32 s53, s3, 5
    v_mov_b32 v34, s53
    v_lshrrev_b32 v8, 5, v0
    v_lshlrev_b32 v11, 2, v8
    v_lshl_add_u32 v11, v10, 3, v11
    s_lshl_b32 s53, s3, 6
    v_add_u32 v36, s53, v11
    v_lshlrev_b32 v37, 3, v0
    v_and_b32 v10, 15, v0
    s_and_b32 s54, s3, 3
    s_lshl_b32 s53, s54, 7
    v_lshl_add_u32 v11, v10, 3, s53
    v_lshl_add_u32 v1, v9, 14, v11
    v_lshl_add_u32 v11, v8, 11, v11
    v_and_b32 v8, 1, v9
    v_lshl_add_u32 v6, v8, 17, v11
    v_lshl_add_u32 v8, v10, 2, v9
    s_lshl_b32 s53, s54, 9
    v_lshl_add_u32 v7, v8, 3, s53
    s_lshl_b32 s53, s3, 8
    v_lshl_add_u32 v39, v8, 2, s53
    s_lshl_b32 s53, s54, 8
    v_lshl_add_u32 v44, v0, 2, s53
    v_lshrrev_b32 v8, 8, v2
    v_lshlrev_b32 v8, 12, v8
    v_and_b32 v10, 0xf0, v2
    v_add_u32 v35, v8, v10
    v_lshrrev_b32 v8, 7, v2
    v_lshlrev_b32 v8, 11, v8
    v_and_b32 v10, 0x70, v2
    v_add_u32 v38, v8, v10
    v_lshrrev_b32 v2, 1, v2
    s_waitcnt vmcnt(5)
    s_cmp_gt_i32 s67, 5
    s_cbranch_scc1 Li_54
    s_waitcnt vmcnt(4)
    s_cmp_gt_i32 s67, 4
    s_cbranch_scc1 Li_54
    s_waitcnt vmcnt(3)
    s_cmp_gt_i32 s67, 3
    s_cbranch_scc1 Li_54
    s_waitcnt vmcnt(2)
Li_54:
    s_xor_b32 s63, s75, 8389632
    buffer_load_dwordx4 v[132:135], v5, s[8:11], s63 offen nt
    v_perm_b32 v65, v140, v136, s57
    v_perm_b32 v69, v140, v136, s58
    v_perm_b32 v73, v141, v137, s57
    v_perm_b32 v77, v141, v137, s58
    v_perm_b32 v81, v142, v138, s57
    v_perm_b32 v85, v142, v138, s58
    v_perm_b32 v89, v143, v139, s57
    v_perm_b32 v93, v143, v139, s58
    s_waitcnt vmcnt(5)
    s_memrealtime s[36:37]
    s_cmp_gt_i32 s67, 5
    s_cbranch_scc1 Li_55
    s_waitcnt vmcnt(4)
    s_cmp_gt_i32 s67, 4
    s_cbranch_scc1 Li_55
    s_waitcnt vmcnt(3)
    s_cmp_gt_i32 s67, 3
    s_cbranch_scc1 Li_55
    s_waitcnt vmcnt(2)
Li_55:
    s_xor_b32 s63, s75, 8390656
    buffer_load_dwordx4 v[136:139], v5, s[8:11], s63 offen nt
    v_mov_b32 v8, 16
    s_mov_b32 s60, 0
Lw_56:
    ds_read_b32 v9, v8
    s_waitcnt lgkmcnt(0)
    v_readfirstlane_b32 s53, v9
    s_cmp_ge_u32 s53, 1
    s_cbranch_scc1 Lwd_57
    s_add_u32 s60, s60, 1
    s_cmp_gt_u32 s60, 0x400000
    s_cbranch_scc1 Lwd_57
    s_sleep 1
    s_branch Lw_56
Lwd_57:
    v_and_b32 v11, 3, v0
    s_and_b32 s54, s3, 3
    v_xor_b32 v11, s54, v11
    v_lshrrev_b32 v10, 4, v0
    v_lshl_add_u32 v10, v10, 2, v11
    s_lshr_b32 s55, s3, 2
    s_lshl_b32 s53, s55, 4
    v_add_u32 v10, s53, v10
    v_bfe_u32 v11, v0, 2, 2
    v_lshlrev_b32 v11, 9, v11
    v_lshl_add_u32 v4, v10, 3, v11
    v_lshlrev_b32 v10, 2, v10
    ds_read_b32 v45, v10 offset:64
    ds_read_b64 v[42:43], v46 offset:192
    ds_read_b32 v3, v46 offset:200
    s_lshl_b32 s66, s69, 17
    s_lshl_b32 s53, s55, 16
    s_add_u32 s66, s66, s53
    s_lshl_b32 s53, s54, 12
    s_add_u32 s66, s66, s53
    s_lshl_b32 s53, s68, 9
    s_add_u32 s66, s66, s53
    s_lshl_b32 s62, s54, 15
    s_add_u32 s62, s62, s53
    s_lshl_b32 s53, s55, 12
    s_add_u32 s62, s62, s53
    s_lshr_b32 s54, s70, 2
    s_lshl_b32 s53, s54, 13
    s_add_u32 s62, s62, s53
    s_and_b32 s55, s2, 7
    s_lshl_b32 s53, s48, 3
    s_add_u32 s53, s53, s55
    s_lshl_b32 s53, s53, 18
    s_add_u32 s62, s62, s53
    s_lshl_b32 s72, s48, 18
    s_lshl_b32 s53, s55, 9
    s_add_u32 s72, s72, s53
    s_lshl_b32 s53, s54, 8
    s_add_u32 s72, s72, s53
    s_add_u32 s72, s72, 1048576
    s_add_u32 s73, s72, 131072
    s_lshl_b32 s50, s2, 12
    s_add_u32 s50, s50, 1048576
    s_lshl_b32 s51, s68, 6
    s_add_u32 s51, s51, s74
    s_lshl_b32 s51, s51, 11
    s_add_u32 s51, s51, 2097152
    s_lshl_b32 s49, s55, 3
    s_or_b32 s49, s49, s70
    s_mov_b32 s49, s49
    s_lshr_b32 s61, s49, 4
    s_lshl_b32 s61, s61, 17
    s_and_b32 s53, s49, 15
    s_lshl_b32 s53, s53, 7
    s_add_u32 s61, s61, s53
    s_add_u32 s61, s61, 2097152
    s_waitcnt lgkmcnt(0)
    v_mov_b32 v13, v3
    v_mov_b32 v41, v3
    v_mov_b32 v160, 0
    v_mov_b32 v161, 0
    v_mov_b32 v162, 0
    v_mov_b32 v163, 0
    s_waitcnt vmcnt(5)
    s_waitcnt lgkmcnt(0)
    s_sub_u32 s36, s36, s64
    s_sub_i32 s36, s36, 1753
    s_ashr_i32 s36, s36, 5
    s_add_i32 s67, s36, 4
    s_cmp_gt_i32 s67, 5
    s_cbranch_scc1 Li_58
    s_waitcnt vmcnt(4)
    s_cmp_gt_i32 s67, 4
    s_cbranch_scc1 Li_58
    s_waitcnt vmcnt(3)
    s_cmp_gt_i32 s67, 3
    s_cbranch_scc1 Li_58
    s_waitcnt vmcnt(2)
Li_58:
    s_xor_b32 s63, s75, 8391680
    buffer_load_dwordx4 v[140:143], v5, s[8:11], s63 offen nt
    v_perm_b32 v66, v148, v144, s57
    v_perm_b32 v70, v148, v144, s58
    v_perm_b32 v74, v149, v145, s57
    v_perm_b32 v78, v149, v145, s58
    v_perm_b32 v82, v150, v146, s57
    v_perm_b32 v86, v150, v146, s58
    v_perm_b32 v90, v151, v147, s57
    v_perm_b32 v94, v151, v147, s58
    s_waitcnt vmcnt(5)
    s_cmp_gt_i32 s67, 5
    s_cbranch_scc1 Li_59
    s_waitcnt vmcnt(4)
    s_cmp_gt_i32 s67, 4
    s_cbranch_scc1 Li_59
    s_waitcnt vmcnt(3)
    s_cmp_gt_i32 s67, 3
    s_cbranch_scc1 Li_59
    s_waitcnt vmcnt(2)
Li_59:
    s_xor_b32 s63, s75, 8392704
    buffer_load_dwordx4 v[144:147], v5, s[8:11], s63 offen nt
    v_mov_b32 v8, 24
    v_mov_b32 v9, 1
    s_waitcnt lgkmcnt(0)
    s_mov_b64 exec, 1
    ds_add_u32 v8, v9
    s_mov_b64 exec, -1
    s_waitcnt vmcnt(5)
    s_memrealtime s[36:37]
    s_cmp_gt_i32 s67, 5
    s_cbranch_scc1 Li_60
    s_waitcnt vmcnt(4)
    s_cmp_gt_i32 s67, 4
    s_cbranch_scc1 Li_60
    s_waitcnt vmcnt(3)
    s_cmp_gt_i32 s67, 3
    s_cbranch_scc1 Li_60
    s_waitcnt vmcnt(2)
Li_60:
    s_xor_b32 s63, s75, 8393728
    buffer_load_dwordx4 v[148:151], v5, s[8:11], s63 offen nt
    v_perm_b32 v67, v156, v152, s57
    v_perm_b32 v71, v156, v152, s58
    v_perm_b32 v75, v157, v153, s57
    v_perm_b32 v79, v157, v153, s58
    v_perm_b32 v83, v158, v154, s57
    v_perm_b32 v87, v158, v154, s58
    v_perm_b32 v91, v159, v155, s57
    v_perm_b32 v95, v159, v155, s58
    v_mfma_f32_16x16x32_bf16 v[96:99], v[64:67], v[52:55], v[96:99]
    v_mfma_f32_16x16x32_bf16 v[100:103], v[68:71], v[52:55], v[100:103]
    v_mfma_f32_16x16x32_bf16 v[104:107], v[72:75], v[52:55], v[104:107]
    v_mfma_f32_16x16x32_bf16 v[108:111], v[76:79], v[52:55], v[108:111]
    v_mfma_f32_16x16x32_bf16 v[112:115], v[80:83], v[52:55], v[112:115]
    v_mfma_f32_16x16x32_bf16 v[116:119], v[84:87], v[52:55], v[116:119]
    v_mfma_f32_16x16x32_bf16 v[120:123], v[88:91], v[52:55], v[120:123]
    v_mfma_f32_16x16x32_bf16 v[124:127], v[92:95], v[52:55], v[124:127]
    s_waitcnt vmcnt(5)
    s_waitcnt lgkmcnt(0)
    s_sub_u32 s36, s36, s64
    s_sub_i32 s36, s36, 1836
    s_ashr_i32 s36, s36, 5
    s_add_i32 s67, s36, 4
    s_cmp_gt_i32 s67, 5
    s_cbranch_scc1 Li_61
    s_waitcnt vmcnt(4)
    s_cmp_gt_i32 s67, 4
    s_cbranch_scc1 Li_61
    s_waitcnt vmcnt(3)
    s_cmp_gt_i32 s67, 3
    s_cbranch_scc1 Li_61
    s_waitcnt vmcnt(2)
Li_61:
    s_xor_b32 s63, s75, 8394752
    buffer_load_dwordx4 v[152:155], v5, s[8:11], s63 offen nt
    s_waitcnt vmcnt(5)
    s_cmp_gt_i32 s67, 5
    s_cbranch_scc1 Li_62
    s_waitcnt vmcnt(4)
    s_cmp_gt_i32 s67, 4
    s_cbranch_scc1 Li_62
    s_waitcnt vmcnt(3)
    s_cmp_gt_i32 s67, 3
    s_cbranch_scc1 Li_62
    s_waitcnt vmcnt(2)
Li_62:
    s_xor_b32 s63, s75, 8395776
    buffer_load_dwordx4 v[156:159], v5, s[8:11], s63 offen nt
    v_perm_b32 v64, v132, v128, s57
    v_perm_b32 v68, v132, v128, s58
    v_perm_b32 v72, v133, v129, s57
    v_perm_b32 v76, v133, v129, s58
    v_perm_b32 v80, v134, v130, s57
    v_perm_b32 v84, v134, v130, s58
    v_perm_b32 v88, v135, v131, s57
    v_perm_b32 v92, v135, v131, s58
    s_waitcnt vmcnt(5)
    s_memrealtime s[36:37]
    s_cmp_gt_i32 s67, 5
    s_cbranch_scc1 Li_63
    s_waitcnt vmcnt(4)
    s_cmp_gt_i32 s67, 4
    s_cbranch_scc1 Li_63
    s_waitcnt vmcnt(3)
    s_cmp_gt_i32 s67, 3
    s_cbranch_scc1 Li_63
    s_waitcnt vmcnt(2)
Li_63:
    s_xor_b32 s63, s75, 12582912
    buffer_load_dwordx4 v[128:131], v5, s[8:11], s63 offen nt
    s_waitcnt vmcnt(5)
    s_waitcnt lgkmcnt(0)
    s_sub_u32 s36, s36, s64
    s_sub_i32 s36, s36, 1919
    s_ashr_i32 s36, s36, 5
    s_add_i32 s67, s36, 4
    s_cmp_gt_i32 s67, 5
    s_cbranch_scc1 Li_64
    s_waitcnt vmcnt(4)
    s_cmp_gt_i32 s67, 4
    s_cbranch_scc1 Li_64
    s_waitcnt vmcnt(3)
    s_cmp_gt_i32 s67, 3
    s_cbranch_scc1 Li_64
    s_waitcnt vmcnt(2)
Li_64:
    s_xor_b32 s63, s75, 12583936
    buffer_load_dwordx4 v[132:135], v5, s[8:11], s63 offen nt
    v_perm_b32 v65, v140, v136, s57
    v_perm_b32 v69, v140, v136, s58
    v_perm_b32 v73, v141, v137, s57
    v_perm_b32 v77, v141, v137, s58
    v_perm_b32 v81, v142, v138, s57
    v_perm_b32 v85, v142, v138, s58
    v_perm_b32 v89, v143, v139, s57
    v_perm_b32 v93, v143, v139, s58
    s_waitcnt vmcnt(5)
    s_cmp_gt_i32 s67, 5
    s_cbranch_scc1 Li_65
    s_waitcnt vmcnt(4)
    s_cmp_gt_i32 s67, 4
    s_cbranch_scc1 Li_65
    s_waitcnt vmcnt(3)
    s_cmp_gt_i32 s67, 3
    s_cbranch_scc1 Li_65
    s_waitcnt vmcnt(2)
Li_65:
    s_xor_b32 s63, s75, 12584960
    buffer_load_dwordx4 v[136:139], v5, s[8:11], s63 offen nt
    s_waitcnt vmcnt(5)
    s_memrealtime s[36:37]
    s_cmp_gt_i32 s67, 5
    s_cbranch_scc1 Li_66
    s_waitcnt vmcnt(4)
    s_cmp_gt_i32 s67, 4
    s_cbranch_scc1 Li_66
    s_waitcnt vmcnt(3)
    s_cmp_gt_i32 s67, 3
    s_cbranch_scc1 Li_66
    s_waitcnt vmcnt(2)
Li_66:
    s_xor_b32 s63, s75, 12585984
    buffer_load_dwordx4 v[140:143], v5, s[8:11], s63 offen nt
    v_perm_b32 v66, v148, v144, s57
    v_perm_b32 v70, v148, v144, s58
    v_perm_b32 v74, v149, v145, s57
    v_perm_b32 v78, v149, v145, s58
    v_perm_b32 v82, v150, v146, s57
    v_perm_b32 v86, v150, v146, s58
    v_perm_b32 v90, v151, v147, s57
    v_perm_b32 v94, v151, v147, s58
    s_waitcnt vmcnt(5)
    s_waitcnt lgkmcnt(0)
    s_sub_u32 s36, s36, s64
    s_sub_i32 s36, s36, 2001
    s_ashr_i32 s36, s36, 5
    s_add_i32 s67, s36, 4
    s_cmp_gt_i32 s67, 5
    s_cbranch_scc1 Li_67
    s_waitcnt vmcnt(4)
    s_cmp_gt_i32 s67, 4
    s_cbranch_scc1 Li_67
    s_waitcnt vmcnt(3)
    s_cmp_gt_i32 s67, 3
    s_cbranch_scc1 Li_67
    s_waitcnt vmcnt(2)
Li_67:
    s_xor_b32 s63, s75, 12587008
    buffer_load_dwordx4 v[144:147], v5, s[8:11], s63 offen nt
    s_waitcnt vmcnt(5)
    s_cmp_gt_i32 s67, 5
    s_cbranch_scc1 Li_68
    s_waitcnt vmcnt(4)
    s_cmp_gt_i32 s67, 4
    s_cbranch_scc1 Li_68
    s_waitcnt vmcnt(3)
    s_cmp_gt_i32 s67, 3
    s_cbranch_scc1 Li_68
    s_waitcnt vmcnt(2)
Li_68:
    s_xor_b32 s63, s75, 12588032
    buffer_load_dwordx4 v[148:151], v5, s[8:11], s63 offen nt
    v_perm_b32 v67, v156, v152, s57
    v_perm_b32 v71, v156, v152, s58
    v_perm_b32 v75, v157, v153, s57
    v_perm_b32 v79, v157, v153, s58
    v_perm_b32 v83, v158, v154, s57
    v_perm_b32 v87, v158, v154, s58
    v_perm_b32 v91, v159, v155, s57
    v_perm_b32 v95, v159, v155, s58
    v_mfma_f32_16x16x32_bf16 v[96:99], v[64:67], v[56:59], v[96:99]
    v_mfma_f32_16x16x32_bf16 v[100:103], v[68:71], v[56:59], v[100:103]
    v_mfma_f32_16x16x32_bf16 v[104:107], v[72:75], v[56:59], v[104:107]
    v_mfma_f32_16x16x32_bf16 v[108:111], v[76:79], v[56:59], v[108:111]
    v_mfma_f32_16x16x32_bf16 v[112:115], v[80:83], v[56:59], v[112:115]
    v_mfma_f32_16x16x32_bf16 v[116:119], v[84:87], v[56:59], v[116:119]
    v_mfma_f32_16x16x32_bf16 v[120:123], v[88:91], v[56:59], v[120:123]
    v_mfma_f32_16x16x32_bf16 v[124:127], v[92:95], v[56:59], v[124:127]
    s_waitcnt vmcnt(5)
    s_memrealtime s[36:37]
    s_cmp_gt_i32 s67, 5
    s_cbranch_scc1 Li_69
    s_waitcnt vmcnt(4)
    s_cmp_gt_i32 s67, 4
    s_cbranch_scc1 Li_69
    s_waitcnt vmcnt(3)
    s_cmp_gt_i32 s67, 3
    s_cbranch_scc1 Li_69
    s_waitcnt vmcnt(2)
Li_69:
    s_xor_b32 s63, s75, 12589056
    buffer_load_dwordx4 v[152:155], v5, s[8:11], s63 offen nt
    s_waitcnt vmcnt(5)
    s_waitcnt lgkmcnt(0)
    s_sub_u32 s36, s36, s64
    s_sub_i32 s36, s36, 2084
    s_ashr_i32 s36, s36, 5
    s_add_i32 s67, s36, 4
    s_cmp_gt_i32 s67, 5
    s_cbranch_scc1 Li_70
    s_waitcnt vmcnt(4)
    s_cmp_gt_i32 s67, 4
    s_cbranch_scc1 Li_70
    s_waitcnt vmcnt(3)
    s_cmp_gt_i32 s67, 3
    s_cbranch_scc1 Li_70
    s_waitcnt vmcnt(2)
Li_70:
    s_xor_b32 s63, s75, 12590080
    buffer_load_dwordx4 v[156:159], v5, s[8:11], s63 offen nt
    v_perm_b32 v64, v132, v128, s57
    v_perm_b32 v68, v132, v128, s58
    v_perm_b32 v72, v133, v129, s57
    v_perm_b32 v76, v133, v129, s58
    v_perm_b32 v80, v134, v130, s57
    v_perm_b32 v84, v134, v130, s58
    v_perm_b32 v88, v135, v131, s57
    v_perm_b32 v92, v135, v131, s58
    s_waitcnt vmcnt(5)
    s_cmp_gt_i32 s67, 5
    s_cbranch_scc1 Li_71
    s_waitcnt vmcnt(4)
    s_cmp_gt_i32 s67, 4
    s_cbranch_scc1 Li_71
    s_waitcnt vmcnt(3)
    s_cmp_gt_i32 s67, 3
    s_cbranch_scc1 Li_71
    s_waitcnt vmcnt(2)
Li_71:
    v_mov_b32_dpp v10, v45 row_newbcast:3 row_mask:0xf bank_mask:0xf
    v_and_b32 v11, 0x7fff0000, v10
    v_and_b32 v10, 0x7fff, v10
    v_cmp_ne_u32 vcc, 0, v10
    s_nop 1
    v_cndmask_b32 v10, v47, v1, vcc
    v_cmp_ne_u32 vcc, 0, v11
    s_nop 1
    v_cndmask_b32 v11, v47, v1, vcc
    s_xor_b32 s56, s66, 12288
    buffer_load_dwordx2 v[164:165], v10, s[28:31], s56 offen nt
    buffer_load_dwordx2 v[166:167], v11, s[28:31], s56 offen offset:2048 nt
    s_waitcnt vmcnt(6)
    s_memrealtime s[36:37]
    s_cmp_gt_i32 s67, 5
    s_cbranch_scc1 Li_72
    s_waitcnt vmcnt(5)
    s_cmp_gt_i32 s67, 4
    s_cbranch_scc1 Li_72
    s_waitcnt vmcnt(4)
    s_cmp_gt_i32 s67, 3
    s_cbranch_scc1 Li_72
    s_waitcnt vmcnt(3)
Li_72:
    v_mov_b32_dpp v10, v45 row_newbcast:0 row_mask:0xf bank_mask:0xf
    v_and_b32 v11, 0x7fff0000, v10
    v_and_b32 v10, 0x7fff, v10
    v_cmp_ne_u32 vcc, 0, v10
    s_nop 1
    v_cndmask_b32 v10, v47, v1, vcc
    v_cmp_ne_u32 vcc, 0, v11
    s_nop 1
    v_cndmask_b32 v11, v47, v1, vcc
    s_xor_b32 s56, s66, 0
    buffer_load_dwordx2 v[48:49], v10, s[28:31], s56 offen nt
    buffer_load_dwordx2 v[50:51], v11, s[28:31], s56 offen offset:2048 nt
    v_perm_b32 v65, v140, v136, s57
    v_perm_b32 v69, v140, v136, s58
    v_perm_b32 v73, v141, v137, s57
    v_perm_b32 v77, v141, v137, s58
    v_perm_b32 v81, v142, v138, s57
    v_perm_b32 v85, v142, v138, s58
    v_perm_b32 v89, v143, v139, s57
    v_perm_b32 v93, v143, v139, s58
    s_waitcnt vmcnt(7)
    s_waitcnt vmcnt(6)
    v_perm_b32 v66, v148, v144, s57
    v_perm_b32 v70, v148, v144, s58
    v_perm_b32 v74, v149, v145, s57
    v_perm_b32 v78, v149, v145, s58
    v_perm_b32 v82, v150, v146, s57
    v_perm_b32 v86, v150, v146, s58
    v_perm_b32 v90, v151, v147, s57
    v_perm_b32 v94, v151, v147, s58
    s_waitcnt vmcnt(5)
    s_waitcnt vmcnt(4)
    v_perm_b32 v67, v156, v152, s57
    v_perm_b32 v71, v156, v152, s58
    v_perm_b32 v75, v157, v153, s57
    v_perm_b32 v79, v157, v153, s58
    v_perm_b32 v83, v158, v154, s57
    v_perm_b32 v87, v158, v154, s58
    v_perm_b32 v91, v159, v155, s57
    v_perm_b32 v95, v159, v155, s58
    v_mfma_f32_16x16x32_bf16 v[96:99], v[64:67], v[60:63], v[96:99]
    v_mfma_f32_16x16x32_bf16 v[100:103], v[68:71], v[60:63], v[100:103]
    v_mfma_f32_16x16x32_bf16 v[104:107], v[72:75], v[60:63], v[104:107]
    v_mfma_f32_16x16x32_bf16 v[108:111], v[76:79], v[60:63], v[108:111]
    v_mfma_f32_16x16x32_bf16 v[112:115], v[80:83], v[60:63], v[112:115]
    v_mfma_f32_16x16x32_bf16 v[116:119], v[84:87], v[60:63], v[116:119]
    v_mfma_f32_16x16x32_bf16 v[120:123], v[88:91], v[60:63], v[120:123]
    v_mfma_f32_16x16x32_bf16 v[124:127], v[92:95], v[60:63], v[124:127]
    v_mov_b32_dpp v10, v45 row_newbcast:1 row_mask:0xf bank_mask:0xf
    v_and_b32 v11, 0x7fff0000, v10
    v_and_b32 v10, 0x7fff, v10
    v_cmp_ne_u32 vcc, 0, v10
    s_nop 1
    v_cndmask_b32 v10, v47, v1, vcc
    v_cmp_ne_u32 vcc, 0, v11
    s_nop 1
    v_cndmask_b32 v11, v47, v1, vcc
    s_xor_b32 s56, s66, 4096
    buffer_load_dwordx2 v[52:53], v10, s[28:31], s56 offen nt
    buffer_load_dwordx2 v[54:55], v11, s[28:31], s56 offen offset:2048 nt
    v_mov_b32_dpp v10, v45 row_newbcast:2 row_mask:0xf bank_mask:0xf
    v_and_b32 v11, 0x7fff0000, v10
    v_and_b32 v10, 0x7fff, v10
    v_cmp_ne_u32 vcc, 0, v10
    s_nop 1
    v_cndmask_b32 v10, v47, v1, vcc
    v_cmp_ne_u32 vcc, 0, v11
    s_nop 1
    v_cndmask_b32 v11, v47, v1, vcc
    s_xor_b32 s56, s66, 8192
    buffer_load_dwordx2 v[56:57], v10, s[28:31], s56 offen nt
    buffer_load_dwordx2 v[58:59], v11, s[28:31], s56 offen offset:2048 nt
    s_xor_b32 s56, s62, 0
    buffer_load_dwordx2 v[16:17], v6, s[16:19], s56 offen nt
    s_xor_b32 s56, s62, 16384
    buffer_load_dwordx2 v[18:19], v6, s[16:19], s56 offen nt
    s_xor_b32 s56, s62, 32768
    buffer_load_dwordx2 v[20:21], v6, s[16:19], s56 offen nt
    s_xor_b32 s56, s62, 49152
    buffer_load_dwordx2 v[22:23], v6, s[16:19], s56 offen nt
    s_mov_b32 exec_lo, 0x00ff00ff
    s_mov_b32 exec_hi, 0x00ff00ff
    ds_write_b128 v32, v[96:99] offset:19072
    ds_write_b128 v32, v[100:103] offset:19136
    ds_write_b128 v32, v[104:107] offset:19200
    ds_write_b128 v32, v[108:111] offset:19264
    ds_write_b128 v32, v[112:115] offset:19328
    ds_write_b128 v32, v[116:119] offset:19392
    ds_write_b128 v32, v[120:123] offset:19456
    ds_write_b128 v32, v[124:127] offset:19520
    s_mov_b64 exec, -1
    s_waitcnt lgkmcnt(0)
    s_barrier
    ds_read_b128 v[152:155], v34 offset:15232
    ds_read_b128 v[156:159], v34 offset:15248
    ds_read_b64 v[64:65], v33 offset:19072
    ds_read_b64 v[66:67], v33 offset:23296
    ds_read_b64 v[68:69], v33 offset:27520
    ds_read_b64 v[70:71], v33 offset:31744
    ds_read_b64 v[72:73], v33 offset:35968
    ds_read_b64 v[74:75], v33 offset:40192
    ds_read_b64 v[76:77], v33 offset:44416
    ds_read_b64 v[78:79], v33 offset:48640
    s_waitcnt lgkmcnt(7)
    v_mul_f32 v12, v64, v152
    v_mul_f32 v14, v65, v152
    s_waitcnt lgkmcnt(6)
    v_fmac_f32 v12, v66, v153
    v_fmac_f32 v14, v67, v153
    s_waitcnt lgkmcnt(5)
    v_fmac_f32 v12, v68, v154
    v_fmac_f32 v14, v69, v154
    s_waitcnt lgkmcnt(4)
    v_fmac_f32 v12, v70, v155
    v_fmac_f32 v14, v71, v155
    s_waitcnt lgkmcnt(3)
    v_fmac_f32 v12, v72, v156
    v_fmac_f32 v14, v73, v156
    s_waitcnt lgkmcnt(2)
    v_fmac_f32 v12, v74, v157
    v_fmac_f32 v14, v75, v157
    s_waitcnt lgkmcnt(1)
    v_fmac_f32 v12, v76, v158
    v_fmac_f32 v14, v77, v158
    s_waitcnt lgkmcnt(0)
    v_fmac_f32 v12, v78, v159
    v_fmac_f32 v14, v79, v159
    v_cvt_pk_bf16_f32 v12, v12, v14
    buffer_store_dwordx2 v[12:13], v2, s[40:43], s50 offen sc1
    s_xor_b32 s56, s62, 65536
    buffer_load_dwordx2 v[24:25], v6, s[16:19], s56 offen nt
    s_xor_b32 s56, s62, 81920
    buffer_load_dwordx2 v[26:27], v6, s[16:19], s56 offen nt
    s_xor_b32 s56, s62, 98304
    buffer_load_dwordx2 v[28:29], v6, s[16:19], s56 offen nt
    s_xor_b32 s56, s62, 114688
    buffer_load_dwordx2 v[30:31], v6, s[16:19], s56 offen nt
    s_waitcnt vmcnt(0)
    buffer_load_dwordx4 v[144:147], v35, s[40:43], s72 offen sc1
    buffer_load_dwordx4 v[148:151], v35, s[40:43], s73 offen sc1
    s_waitcnt vmcnt(10)
    v_perm_b32 v80, v50, v48, s57
    v_perm_b32 v81, v50, v48, s58
    v_perm_b32 v82, v51, v49, s57
    v_perm_b32 v83, v51, v49, s58
    v_perm_b32 v84, v54, v52, s57
    v_perm_b32 v85, v54, v52, s58
    v_perm_b32 v86, v55, v53, s57
    v_perm_b32 v87, v55, v53, s58
    v_perm_b32 v88, v58, v56, s57
    v_perm_b32 v89, v58, v56, s58
    v_perm_b32 v90, v59, v57, s57
    v_perm_b32 v91, v59, v57, s58
    v_perm_b32 v92, v166, v164, s57
    v_perm_b32 v93, v166, v164, s58
    v_perm_b32 v94, v167, v165, s57
    v_perm_b32 v95, v167, v165, s58
    v_dot2c_f32_bf16_dpp v160, v45, v80 row_newbcast:0 row_mask:0xf bank_mask:0xf
    v_dot2c_f32_bf16_dpp v161, v45, v81 row_newbcast:0 row_mask:0xf bank_mask:0xf
    v_dot2c_f32_bf16_dpp v162, v45, v82 row_newbcast:0 row_mask:0xf bank_mask:0xf
    v_dot2c_f32_bf16_dpp v163, v45, v83 row_newbcast:0 row_mask:0xf bank_mask:0xf
    v_dot2c_f32_bf16_dpp v160, v45, v84 row_newbcast:1 row_mask:0xf bank_mask:0xf
    v_dot2c_f32_bf16_dpp v161, v45, v85 row_newbcast:1 row_mask:0xf bank_mask:0xf
    v_dot2c_f32_bf16_dpp v162, v45, v86 row_newbcast:1 row_mask:0xf bank_mask:0xf
    v_dot2c_f32_bf16_dpp v163, v45, v87 row_newbcast:1 row_mask:0xf bank_mask:0xf
    v_dot2c_f32_bf16_dpp v160, v45, v88 row_newbcast:2 row_mask:0xf bank_mask:0xf
    v_dot2c_f32_bf16_dpp v161, v45, v89 row_newbcast:2 row_mask:0xf bank_mask:0xf
    v_dot2c_f32_bf16_dpp v162, v45, v90 row_newbcast:2 row_mask:0xf bank_mask:0xf
    v_dot2c_f32_bf16_dpp v163, v45, v91 row_newbcast:2 row_mask:0xf bank_mask:0xf
    v_dot2c_f32_bf16_dpp v160, v45, v92 row_newbcast:3 row_mask:0xf bank_mask:0xf
    v_dot2c_f32_bf16_dpp v161, v45, v93 row_newbcast:3 row_mask:0xf bank_mask:0xf
    v_dot2c_f32_bf16_dpp v162, v45, v94 row_newbcast:3 row_mask:0xf bank_mask:0xf
    v_dot2c_f32_bf16_dpp v163, v45, v95 row_newbcast:3 row_mask:0xf bank_mask:0xf
    v_mov_b32 v72, 0
    v_mov_b32 v73, 0
    v_mov_b32 v74, 0
    v_mov_b32 v75, 0
    v_mul_f32 v160, v160, v43
    v_mul_f32 v161, v161, v43
    v_mul_f32 v162, v162, v43
    v_mul_f32 v163, v163, v43
    s_waitcnt vmcnt(2)
    v_perm_b32 v128, v18, v16, s57
    v_perm_b32 v129, v18, v16, s58
    v_perm_b32 v130, v19, v17, s57
    v_perm_b32 v131, v19, v17, s58
    v_perm_b32 v132, v22, v20, s57
    v_perm_b32 v133, v22, v20, s58
    v_perm_b32 v134, v23, v21, s57
    v_perm_b32 v135, v23, v21, s58
    v_perm_b32 v136, v26, v24, s57
    v_perm_b32 v137, v26, v24, s58
    v_perm_b32 v138, v27, v25, s57
    v_perm_b32 v139, v27, v25, s58
    v_perm_b32 v140, v30, v28, s57
    v_perm_b32 v141, v30, v28, s58
    v_perm_b32 v142, v31, v29, s57
    v_perm_b32 v143, v31, v29, s58
    s_waitcnt vmcnt(0)
    s_mov_b32 s60, 0
Lchk_73:
    v_xor_b32 v8, v145, v3
    v_xor_b32 v9, v147, v3
    v_or_b32 v8, v8, v9
    v_xor_b32 v9, v149, v3
    v_or_b32 v8, v8, v9
    v_xor_b32 v9, v151, v3
    v_or_b32 v8, v8, v9
    v_cmp_ne_u32 vcc, 0, v8
    s_and_b64 exec, exec, vcc
    s_cbranch_scc0 Ldone_74
    s_add_u32 s60, s60, 1
    s_cmp_gt_u32 s60, 0x40000
    s_cbranch_scc1 Ldone_74
    s_sleep 1
    buffer_load_dwordx4 v[144:147], v35, s[40:43], s72 offen sc1
    buffer_load_dwordx4 v[148:151], v35, s[40:43], s73 offen sc1
    s_waitcnt vmcnt(0)
    s_branch Lchk_73
Ldone_74:
    s_mov_b64 exec, -1
    v_and_b32 v145, 0xffff0000, v144
    v_lshlrev_b32 v144, 16, v144
    v_and_b32 v147, 0xffff0000, v146
    v_lshlrev_b32 v146, 16, v146
    v_and_b32 v149, 0xffff0000, v148
    v_lshlrev_b32 v148, 16, v148
    v_and_b32 v151, 0xffff0000, v150
    v_lshlrev_b32 v150, 16, v150
    v_add_f32 v144, v144, v148
    v_add_f32 v145, v145, v149
    v_add_f32 v146, v146, v150
    v_add_f32 v147, v147, v151
    s_nop 0
    v_permlane32_swap_b32 v144, v146
    v_permlane32_swap_b32 v145, v147
    v_add_f32 v144, v144, v146
    v_add_f32 v145, v145, v147
    s_nop 1
    v_permlane16_swap_b32 v144, v145
    v_add_f32 v144, v144, v145
    ds_write_b32 v39, v144 offset:15488
    s_waitcnt lgkmcnt(0)
    s_barrier
    ds_read_b64 v[64:65], v4 offset:15488
    ds_read_b64 v[66:67], v4 offset:15744
    s_waitcnt lgkmcnt(0)
    v_add_f32 v64, v64, v66
    v_add_f32 v65, v65, v67
    s_nop 0
    v_add_f32_dpp v64, v64, v64 row_ror:4 row_mask:0xf bank_mask:0xf
    v_add_f32_dpp v65, v65, v65 row_ror:4 row_mask:0xf bank_mask:0xf
    s_nop 0
    v_add_f32_dpp v64, v64, v64 row_ror:8 row_mask:0xf bank_mask:0xf
    v_add_f32_dpp v65, v65, v65 row_ror:8 row_mask:0xf bank_mask:0xf
    v_cvt_pk_bf16_f32 v8, v64, v65
    s_nop 1
    v_dot2c_f32_bf16_dpp v72, v8, v128 row_newbcast:0 row_mask:0xf bank_mask:0xf
    v_dot2c_f32_bf16_dpp v73, v8, v129 row_newbcast:0 row_mask:0xf bank_mask:0xf
    v_dot2c_f32_bf16_dpp v74, v8, v130 row_newbcast:0 row_mask:0xf bank_mask:0xf
    v_dot2c_f32_bf16_dpp v75, v8, v131 row_newbcast:0 row_mask:0xf bank_mask:0xf
    v_dot2c_f32_bf16_dpp v72, v8, v132 row_newbcast:1 row_mask:0xf bank_mask:0xf
    v_dot2c_f32_bf16_dpp v73, v8, v133 row_newbcast:1 row_mask:0xf bank_mask:0xf
    v_dot2c_f32_bf16_dpp v74, v8, v134 row_newbcast:1 row_mask:0xf bank_mask:0xf
    v_dot2c_f32_bf16_dpp v75, v8, v135 row_newbcast:1 row_mask:0xf bank_mask:0xf
    v_dot2c_f32_bf16_dpp v72, v8, v136 row_newbcast:2 row_mask:0xf bank_mask:0xf
    v_dot2c_f32_bf16_dpp v73, v8, v137 row_newbcast:2 row_mask:0xf bank_mask:0xf
    v_dot2c_f32_bf16_dpp v74, v8, v138 row_newbcast:2 row_mask:0xf bank_mask:0xf
    v_dot2c_f32_bf16_dpp v75, v8, v139 row_newbcast:2 row_mask:0xf bank_mask:0xf
    v_dot2c_f32_bf16_dpp v72, v8, v140 row_newbcast:3 row_mask:0xf bank_mask:0xf
    v_dot2c_f32_bf16_dpp v73, v8, v141 row_newbcast:3 row_mask:0xf bank_mask:0xf
    v_dot2c_f32_bf16_dpp v74, v8, v142 row_newbcast:3 row_mask:0xf bank_mask:0xf
    v_dot2c_f32_bf16_dpp v75, v8, v143 row_newbcast:3 row_mask:0xf bank_mask:0xf
    v_fmac_f32 v160, v72, v42
    v_fmac_f32 v161, v73, v42
    v_fmac_f32 v162, v74, v42
    v_fmac_f32 v163, v75, v42
    s_nop 0
    v_permlane32_swap_b32 v160, v162
    v_permlane32_swap_b32 v161, v163
    v_add_f32 v160, v160, v162
    v_add_f32 v161, v161, v163
    s_nop 1
    v_permlane16_swap_b32 v160, v161
    v_add_f32 v40, v160, v161
    s_cmp_lt_u32 s3, 4
    s_cbranch_scc1 L_lo
    ds_write_b32 v44, v40 offset:18048
    s_waitcnt lgkmcnt(0)
    s_barrier
    s_branch L_st
L_lo:
    s_barrier
    ds_read_b32 v8, v44 offset:18048
    s_waitcnt lgkmcnt(0)
    v_add_f32 v40, v40, v8
    buffer_store_dwordx2 v[40:41], v7, s[40:43], s51 offen sc1
L_st:
    s_cmp_ge_u32 s2, 64
    s_cbranch_scc1 L_fin
    s_waitcnt vmcnt(0)
    s_mov_b32 s60, 0
    buffer_load_dwordx4 v[64:67], v38, s[40:43], s61 offen sc1
    s_waitcnt vmcnt(0)
Lchk_75:
    v_xor_b32 v8, v65, v3
    v_xor_b32 v9, v67, v3
    v_or_b32 v8, v8, v9
    v_cmp_ne_u32 vcc, 0, v8
    s_and_b64 exec, exec, vcc
    s_cbranch_scc0 Ldone_76
    s_add_u32 s60, s60, 1
    s_cmp_gt_u32 s60, 0x40000
    s_cbranch_scc1 Ldone_76
    s_sleep 1
    buffer_load_dwordx4 v[64:67], v38, s[40:43], s61 offen sc1
    s_waitcnt vmcnt(0)
    s_branch Lchk_75
Ldone_76:
    s_mov_b64 exec, -1
    v_permlane32_swap_b32 v64, v66
    v_add_f32 v64, v64, v66
    s_nop 1
    v_add_f32_dpp v64, v64, v64 row_ror:8 row_mask:0xf bank_mask:0xf
    v_mov_b32 v9, v64
    s_nop 1
    v_permlane16_swap_b32 v64, v9
    v_add_f32 v64, v64, v9
    ds_write_b32 v36, v64 offset:17536
    s_waitcnt lgkmcnt(0)
    s_barrier
    s_cmp_lg_u32 s3, 0
    s_cbranch_scc1 L_fin
L_nb2:
    ds_read_b64 v[64:65], v37 offset:17536
    v_lshlrev_b32 v10, 2, v0
    s_lshl_b32 s53, s49, 5
    s_waitcnt lgkmcnt(0)
    v_add_f32_dpp v64, v64, v64 row_ror:8 row_mask:0xf bank_mask:0xf
    v_add_f32_dpp v65, v65, v65 row_ror:8 row_mask:0xf bank_mask:0xf
    v_mov_b32 v8, v64
    v_mov_b32 v9, v65
    s_nop 0
    v_permlane16_swap_b32 v64, v8
    v_permlane16_swap_b32 v65, v9
    v_add_f32 v64, v64, v8
    v_add_f32 v65, v65, v9
    v_mov_b32 v8, v64
    v_mov_b32 v9, v65
    s_nop 0
    v_permlane32_swap_b32 v64, v8
    v_permlane32_swap_b32 v65, v9
    v_add_f32 v64, v64, v8
    v_add_f32 v65, v65, v9
    v_cvt_pk_bf16_f32 v8, v64, v65
    s_mov_b64 exec, 0xff
    buffer_store_dword v8, v10, s[44:47], s53 offen
    s_cmp_lg_u32 s2, 0
    s_cbranch_scc1 L_fin
    s_mov_b64 exec, 1
    buffer_store_dword v3, off, s[40:43], 0
L_fin:
L_end:
    s_endpgm
L_comm:
    s_setprio 3
    s_mov_b32 s67, 0
    v_mov_b32 v8, 0
    v_lshlrev_b32 v1, 2, v0
    s_mov_b64 exec, 0xffff
    ds_write_b32 v1, v8
    s_mov_b64 exec, -1
    s_mov_b32 s38, 2048
    s_mov_b32 s39, 0x20000
    s_waitcnt lgkmcnt(0)
    s_barrier
    s_mov_b64 s[32:33], s[76:77]
    s_mov_b64 s[36:37], s[94:95]
    s_and_b32 s68, s70, 3
    s_lshr_b32 s69, s70, 2
    s_lshl_b32 s53, s71, 1
    s_or_b32 s69, s69, s53
    s_lshr_b32 s74, s2, 5
    s_lshl_b32 s74, s74, 3
    s_and_b32 s53, s2, 7
    s_or_b32 s74, s74, s53
    s_mov_b32 s42, 2621440
    s_mov_b32 s43, 0x20000
    buffer_load_dword v3, off, s[40:43], 0 sc1
    v_lshlrev_b32 v32, 3, v0
    v_lshrrev_b32 v8, 3, v0
    v_and_b32 v9, 7, v0
    v_lshlrev_b32 v33, 10, v8
    v_lshl_add_u32 v33, v9, 4, v33
    v_lshrrev_b32 v8, 5, v0
    v_and_b32 v9, 31, v0
    v_lshlrev_b32 v34, 10, v8
    v_lshl_add_u32 v34, v9, 4, v34
    v_mul_u32_u24 v8, 272, v8
    v_lshl_add_u32 v35, v9, 3, v8
    v_add_u32 v36, 256, v32
    s_lshl_b32 s54, s71, 13
    s_add_u32 s54, s54, 262144
    s_lshl_b32 s55, s70, 10
    s_add_u32 s61, s54, s55
    s_lshl_b32 s55, s70, 7
    s_add_u32 s50, s54, s55
    s_lshl_b32 s54, s71, 9
    s_lshl_b32 s55, s70, 6
    s_add_u32 s62, s54, s55
    s_add_u32 s62, s62, 65536
    s_lshl_b32 s51, s48, 12
    s_add_u32 s51, s51, 65536
    s_waitcnt vmcnt(0)
    v_add_u32 v3, 1, v3
    v_mov_b32 v8, 0
    s_mov_b32 s60, 0
Lw_77:
    ds_read_b32 v9, v8
    s_waitcnt lgkmcnt(0)
    v_readfirstlane_b32 s53, v9
    s_cmp_ge_u32 s53, 8
    s_cbranch_scc1 Lwd_78
    s_add_u32 s60, s60, 1
    s_cmp_gt_u32 s60, 0x400000
    s_cbranch_scc1 Lwd_78
    s_sleep 1
    s_branch Lw_77
Lwd_78:
    ds_read2st64_b64 v[16:19], v36 offset0:0 offset1:1
    ds_read2st64_b64 v[20:23], v36 offset0:2 offset1:3
    ds_read2st64_b64 v[24:27], v36 offset0:4 offset1:5
    ds_read2st64_b64 v[28:31], v36 offset0:6 offset1:7
    s_waitcnt lgkmcnt(0)
    v_add_f32 v16, v16, v18
    v_add_f32 v17, v17, v19
    v_add_f32 v20, v20, v22
    v_add_f32 v21, v21, v23
    v_add_f32 v24, v24, v26
    v_add_f32 v25, v25, v27
    v_add_f32 v28, v28, v30
    v_add_f32 v29, v29, v31
    v_add_f32 v16, v16, v20
    v_add_f32 v17, v17, v21
    v_add_f32 v24, v24, v28
    v_add_f32 v25, v25, v29
    v_add_f32 v16, v16, v24
    v_add_f32 v17, v17, v25
    v_mov_b32 v18, v17
    v_mov_b32 v17, v3
    v_mov_b32 v19, v3
    buffer_store_dwordx4 v[16:19], v5, s[40:43], s61 offen offset:0
    s_waitcnt vmcnt(0)
    s_mov_b32 s60, 0
    buffer_load_dwordx4 v[40:43], v33, s[40:43], s50 offen sc1
    s_waitcnt vmcnt(0)
Lchk_79:
    v_xor_b32 v8, v41, v3
    v_xor_b32 v9, v43, v3
    v_or_b32 v8, v8, v9
    v_cmp_ne_u32 vcc, 0, v8
    s_and_b64 exec, exec, vcc
    s_cbranch_scc0 Ldone_80
    s_add_u32 s60, s60, 1
    s_cmp_gt_u32 s60, 0x40000
    s_cbranch_scc1 Ldone_80
    s_and_b32 s53, s60, 7
    s_cbranch_scc1 Lnw_81
    buffer_wbl2 sc1
    s_waitcnt vmcnt(0)
    s_mov_b32 s67, 1
Lnw_81:
    s_sleep 4
    buffer_load_dwordx4 v[40:43], v33, s[40:43], s50 offen sc1
    s_waitcnt vmcnt(0)
    s_branch Lchk_79
Ldone_80:
    s_mov_b64 exec, -1
    v_add_f32_dpp v40, v40, v40 row_ror:8 row_mask:0xf bank_mask:0xf
    v_add_f32_dpp v42, v42, v42 row_ror:8 row_mask:0xf bank_mask:0xf
    v_mov_b32 v8, v40
    v_mov_b32 v9, v42
    s_nop 0
    v_permlane16_swap_b32 v40, v8
    v_permlane16_swap_b32 v42, v9
    v_add_f32 v40, v40, v8
    v_add_f32 v42, v42, v9
    v_mov_b32 v8, v40
    v_mov_b32 v9, v42
    s_nop 0
    v_permlane32_swap_b32 v40, v8
    v_permlane32_swap_b32 v42, v9
    v_add_f32 v40, v40, v8
    v_add_f32 v42, v42, v9
    v_cvt_pk_bf16_f32 v40, v40, v42
    s_mov_b64 exec, 255
    buffer_store_dwordx2 v[40:41], v32, s[40:43], s62 offen sc1
    s_mov_b64 exec, -1
    buffer_load_dwordx4 v[96:99], v5, s[32:35], 0 offen
    buffer_load_dwordx4 v[100:103], v5, s[32:35], 0 offen offset:1024
    buffer_load_dwordx4 v[104:107], v5, s[36:39], 0 offen
    buffer_load_dwordx4 v[108:111], v5, s[36:39], 0 offen offset:1024
    s_lshl_b32 s52, s71, 14
    s_add_u32 s52, s52, 524288
    s_lshl_b32 s55, s70, 11
    s_add_u32 s61, s52, s55
    s_and_b32 s55, s69, 1
    s_lshl_b32 s55, s55, 9
    s_add_u32 s52, s52, s55
    v_mov_b32 v8, 4
    s_mov_b32 s60, 0
Lw_82:
    ds_read_b32 v9, v8
    s_waitcnt lgkmcnt(0)
    v_readfirstlane_b32 s53, v9
    s_cmp_ge_u32 s53, 8
    s_cbranch_scc1 Lwd_83
    s_add_u32 s60, s60, 1
    s_cmp_gt_u32 s60, 0x400000
    s_cbranch_scc1 Lwd_83
    s_sleep 1
    s_branch Lw_82
Lwd_83:
    ds_read2st64_b64 v[16:19], v36 offset0:8 offset1:9
    ds_read2st64_b64 v[20:23], v36 offset0:10 offset1:11
    ds_read2st64_b64 v[24:27], v36 offset0:12 offset1:13
    ds_read2st64_b64 v[28:31], v36 offset0:14 offset1:15
    s_waitcnt lgkmcnt(0)
    v_add_f32 v16, v16, v18
    v_add_f32 v17, v17, v19
    v_add_f32 v20, v20, v22
    v_add_f32 v21, v21, v23
    v_add_f32 v24, v24, v26
    v_add_f32 v25, v25, v27
    v_add_f32 v28, v28, v30
    v_add_f32 v29, v29, v31
    v_add_f32 v16, v16, v20
    v_add_f32 v17, v17, v21
    v_add_f32 v24, v24, v28
    v_add_f32 v25, v25, v29
    v_add_f32 v16, v16, v24
    v_add_f32 v17, v17, v25
    v_mov_b32 v18, v17
    v_mov_b32 v17, v3
    v_mov_b32 v19, v3
    buffer_store_dwordx4 v[16:19], v5, s[40:43], s61 offen offset:0
    ds_read2st64_b64 v[48:51], v36 offset0:16 offset1:17
    ds_read2st64_b64 v[52:55], v36 offset0:18 offset1:19
    ds_read2st64_b64 v[56:59], v36 offset0:20 offset1:21
    ds_read2st64_b64 v[60:63], v36 offset0:22 offset1:23
    s_waitcnt lgkmcnt(0)
    v_add_f32 v48, v48, v50
    v_add_f32 v49, v49, v51
    v_add_f32 v52, v52, v54
    v_add_f32 v53, v53, v55
    v_add_f32 v56, v56, v58
    v_add_f32 v57, v57, v59
    v_add_f32 v60, v60, v62
    v_add_f32 v61, v61, v63
    v_add_f32 v48, v48, v52
    v_add_f32 v49, v49, v53
    v_add_f32 v56, v56, v60
    v_add_f32 v57, v57, v61
    v_add_f32 v48, v48, v56
    v_add_f32 v49, v49, v57
    v_mov_b32 v50, v49
    v_mov_b32 v49, v3
    v_mov_b32 v51, v3
    buffer_store_dwordx4 v[48:51], v5, s[40:43], s61 offen offset:1024
    s_cmp_eq_u32 s67, 0
    s_cbranch_scc1 L_nwb
    s_waitcnt vmcnt(0)
    buffer_wbl2 sc1
    s_waitcnt vmcnt(0)
L_nwb:
    s_waitcnt vmcnt(2)
    v_mov_b32 v12, 0
    v_lshlrev_b32 v8, 16, v96
    v_and_b32 v9, 0xffff0000, v96
    v_lshlrev_b32 v10, 16, v104
    v_and_b32 v11, 0xffff0000, v104
    v_mul_f32 v8, v8, v10
    v_mul_f32 v9, v9, v11
    v_cvt_pk_bf16_f32 v8, v8, v9
    v_lshlrev_b32 v9, 16, v8
    v_and_b32 v8, 0xffff0000, v8
    v_add_f32 v12, v12, v8
    v_add_f32 v12, v12, v9
    v_lshlrev_b32 v8, 16, v97
    v_and_b32 v9, 0xffff0000, v97
    v_lshlrev_b32 v10, 16, v105
    v_and_b32 v11, 0xffff0000, v105
    v_mul_f32 v8, v8, v10
    v_mul_f32 v9, v9, v11
    v_cvt_pk_bf16_f32 v8, v8, v9
    v_lshlrev_b32 v9, 16, v8
    v_and_b32 v8, 0xffff0000, v8
    v_add_f32 v12, v12, v8
    v_add_f32 v12, v12, v9
    v_lshlrev_b32 v8, 16, v98
    v_and_b32 v9, 0xffff0000, v98
    v_lshlrev_b32 v10, 16, v106
    v_and_b32 v11, 0xffff0000, v106
    v_mul_f32 v8, v8, v10
    v_mul_f32 v9, v9, v11
    v_cvt_pk_bf16_f32 v8, v8, v9
    v_lshlrev_b32 v9, 16, v8
    v_and_b32 v8, 0xffff0000, v8
    v_add_f32 v12, v12, v8
    v_add_f32 v12, v12, v9
    v_lshlrev_b32 v8, 16, v99
    v_and_b32 v9, 0xffff0000, v99
    v_lshlrev_b32 v10, 16, v107
    v_and_b32 v11, 0xffff0000, v107
    v_mul_f32 v8, v8, v10
    v_mul_f32 v9, v9, v11
    v_cvt_pk_bf16_f32 v8, v8, v9
    v_lshlrev_b32 v9, 16, v8
    v_and_b32 v8, 0xffff0000, v8
    v_add_f32 v12, v12, v8
    v_add_f32 v12, v12, v9
    v_lshlrev_b32 v8, 16, v100
    v_and_b32 v9, 0xffff0000, v100
    v_lshlrev_b32 v10, 16, v108
    v_and_b32 v11, 0xffff0000, v108
    v_mul_f32 v8, v8, v10
    v_mul_f32 v9, v9, v11
    v_cvt_pk_bf16_f32 v8, v8, v9
    v_lshlrev_b32 v9, 16, v8
    v_and_b32 v8, 0xffff0000, v8
    v_add_f32 v12, v12, v8
    v_add_f32 v12, v12, v9
    v_lshlrev_b32 v8, 16, v101
    v_and_b32 v9, 0xffff0000, v101
    v_lshlrev_b32 v10, 16, v109
    v_and_b32 v11, 0xffff0000, v109
    v_mul_f32 v8, v8, v10
    v_mul_f32 v9, v9, v11
    v_cvt_pk_bf16_f32 v8, v8, v9
    v_lshlrev_b32 v9, 16, v8
    v_and_b32 v8, 0xffff0000, v8
    v_add_f32 v12, v12, v8
    v_add_f32 v12, v12, v9
    v_lshlrev_b32 v8, 16, v102
    v_and_b32 v9, 0xffff0000, v102
    v_lshlrev_b32 v10, 16, v110
    v_and_b32 v11, 0xffff0000, v110
    v_mul_f32 v8, v8, v10
    v_mul_f32 v9, v9, v11
    v_cvt_pk_bf16_f32 v8, v8, v9
    v_lshlrev_b32 v9, 16, v8
    v_and_b32 v8, 0xffff0000, v8
    v_add_f32 v12, v12, v8
    v_add_f32 v12, v12, v9
    v_lshlrev_b32 v8, 16, v103
    v_and_b32 v9, 0xffff0000, v103
    v_lshlrev_b32 v10, 16, v111
    v_and_b32 v11, 0xffff0000, v111
    v_mul_f32 v8, v8, v10
    v_mul_f32 v9, v9, v11
    v_cvt_pk_bf16_f32 v8, v8, v9
    v_lshlrev_b32 v9, 16, v8
    v_and_b32 v8, 0xffff0000, v8
    v_add_f32 v12, v12, v8
    v_add_f32 v12, v12, v9
    s_nop 1
    v_add_f32_dpp v12, v12, v12 row_ror:1 row_mask:0xf bank_mask:0xf
    s_nop 1
    v_add_f32_dpp v12, v12, v12 row_ror:2 row_mask:0xf bank_mask:0xf
    s_nop 1
    v_add_f32_dpp v12, v12, v12 row_ror:4 row_mask:0xf bank_mask:0xf
    s_nop 1
    v_add_f32_dpp v12, v12, v12 row_ror:8 row_mask:0xf bank_mask:0xf
    v_mov_b32 v11, v12
    s_nop 1
    v_permlane16_swap_b32 v12, v11
    v_add_f32 v12, v12, v11
    v_mov_b32 v11, v12
    s_nop 1
    v_permlane32_swap_b32 v12, v11
    v_add_f32 v12, v12, v11
    v_cvt_pk_bf16_f32 v8, v12, v12
    v_and_b32 v8, 0xffff0000, v8
    v_mul_f32 v8, 0xbfb8aa3b, v8
    v_exp_f32 v8, v8
    s_nop 0
    v_add_f32 v8, 1.0, v8
    v_rcp_f32 v8, v8
    s_nop 0
    v_cvt_pk_bf16_f32 v8, v8, v8
    v_and_b32 v8, 0xffff0000, v8
    v_sub_f32 v9, 1.0, v8
    v_cvt_pk_bf16_f32 v9, v9, v9
    v_and_b32 v9, 0xffff0000, v9
    v_mov_b32 v10, 0
    s_mov_b64 exec, 1
    ds_write_b64 v10, v[8:9] offset:192
    ds_write_b32 v10, v3 offset:200
    s_mov_b64 exec, -1
    v_mov_b32 v8, 20
    s_mov_b32 s60, 0
Lw_84:
    ds_read_b32 v9, v8
    s_waitcnt lgkmcnt(0)
    v_readfirstlane_b32 s53, v9
    s_cmp_ge_u32 s53, 6
    s_cbranch_scc1 Lwd_85
    s_add_u32 s60, s60, 1
    s_cmp_gt_u32 s60, 0x400000
    s_cbranch_scc1 Lwd_85
    s_sleep 4
    s_branch Lw_84
Lwd_85:
    s_mov_b32 s60, 0
    buffer_load_dwordx4 v[64:67], v5, s[40:43], s51 offen offset:0 sc1
    buffer_load_dwordx4 v[68:71], v5, s[40:43], s51 offen offset:1024 sc1
    buffer_load_dwordx4 v[72:75], v5, s[40:43], s51 offen offset:2048 sc1
    buffer_load_dwordx4 v[76:79], v5, s[40:43], s51 offen offset:3072 sc1
    s_waitcnt vmcnt(0)
Lchk_86:
    v_xor_b32 v10, v65, v3
    v_xor_b32 v11, v67, v3
    v_or_b32 v10, v10, v11
    v_xor_b32 v11, v69, v3
    v_or_b32 v10, v10, v11
    v_xor_b32 v11, v71, v3
    v_or_b32 v10, v10, v11
    v_xor_b32 v11, v73, v3
    v_or_b32 v10, v10, v11
    v_xor_b32 v11, v75, v3
    v_or_b32 v10, v10, v11
    v_xor_b32 v11, v77, v3
    v_or_b32 v10, v10, v11
    v_xor_b32 v11, v79, v3
    v_or_b32 v10, v10, v11
    v_cmp_ne_u32 vcc, 0, v10
    s_and_b64 exec, exec, vcc
    s_cbranch_scc0 Ldone_87
    s_add_u32 s60, s60, 1
    s_cmp_gt_u32 s60, 0x40000
    s_cbranch_scc1 Ldone_87
    s_and_b32 s53, s60, 7
    s_cbranch_scc1 Lnw_88
    buffer_wbl2 sc1
    s_waitcnt vmcnt(0)
    s_mov_b32 s67, 1
Lnw_88:
    s_sleep 16
    buffer_load_dwordx4 v[64:67], v5, s[40:43], s51 offen offset:0 sc1
    buffer_load_dwordx4 v[68:71], v5, s[40:43], s51 offen offset:1024 sc1
    buffer_load_dwordx4 v[72:75], v5, s[40:43], s51 offen offset:2048 sc1
    buffer_load_dwordx4 v[76:79], v5, s[40:43], s51 offen offset:3072 sc1
    s_waitcnt vmcnt(0)
    s_branch Lchk_86
Ldone_87:
    s_mov_b64 exec, -1
    v_mov_b32 v65, v66
    v_mov_b32 v69, v70
    v_mov_b32 v73, v74
    v_mov_b32 v77, v78
    ds_write_b64 v35, v[64:65] offset:12544
    ds_write_b64 v35, v[68:69] offset:13088
    ds_write_b64 v35, v[72:73] offset:13632
    ds_write_b64 v35, v[76:77] offset:14176
    v_mov_b32 v8, 8
    v_mov_b32 v9, 1
    s_waitcnt lgkmcnt(0)
    s_mov_b64 exec, 1
    ds_add_u32 v8, v9
    s_mov_b64 exec, -1
    s_add_u32 s54, s52, 4096
    s_add_u32 s55, s52, 8192
    s_add_u32 s56, s52, 12288
    s_mov_b32 s60, 0
    buffer_load_dwordx4 v[64:67], v34, s[40:43], s52 offen offset:0 sc1
    buffer_load_dwordx4 v[68:71], v34, s[40:43], s52 offen offset:2048 sc1
    buffer_load_dwordx4 v[72:75], v34, s[40:43], s54 offen offset:0 sc1
    buffer_load_dwordx4 v[76:79], v34, s[40:43], s54 offen offset:2048 sc1
    buffer_load_dwordx4 v[80:83], v34, s[40:43], s55 offen offset:0 sc1
    buffer_load_dwordx4 v[84:87], v34, s[40:43], s55 offen offset:2048 sc1
    buffer_load_dwordx4 v[88:91], v34, s[40:43], s56 offen offset:0 sc1
    buffer_load_dwordx4 v[92:95], v34, s[40:43], s56 offen offset:2048 sc1
    s_waitcnt vmcnt(0)
Lchk_89:
    v_xor_b32 v10, v65, v3
    v_xor_b32 v11, v67, v3
    v_or_b32 v10, v10, v11
    v_xor_b32 v11, v69, v3
    v_or_b32 v10, v10, v11
    v_xor_b32 v11, v71, v3
    v_or_b32 v10, v10, v11
    v_xor_b32 v11, v73, v3
    v_or_b32 v10, v10, v11
    v_xor_b32 v11, v75, v3
    v_or_b32 v10, v10, v11
    v_xor_b32 v11, v77, v3
    v_or_b32 v10, v10, v11
    v_xor_b32 v11, v79, v3
    v_or_b32 v10, v10, v11
    v_xor_b32 v11, v81, v3
    v_or_b32 v10, v10, v11
    v_xor_b32 v11, v83, v3
    v_or_b32 v10, v10, v11
    v_xor_b32 v11, v85, v3
    v_or_b32 v10, v10, v11
    v_xor_b32 v11, v87, v3
    v_or_b32 v10, v10, v11
    v_xor_b32 v11, v89, v3
    v_or_b32 v10, v10, v11
    v_xor_b32 v11, v91, v3
    v_or_b32 v10, v10, v11
    v_xor_b32 v11, v93, v3
    v_or_b32 v10, v10, v11
    v_xor_b32 v11, v95, v3
    v_or_b32 v10, v10, v11
    v_cmp_ne_u32 vcc, 0, v10
    s_and_b64 exec, exec, vcc
    s_cbranch_scc0 Ldone_90
    s_add_u32 s60, s60, 1
    s_cmp_gt_u32 s60, 0x40000
    s_cbranch_scc1 Ldone_90
    s_and_b32 s53, s60, 7
    s_cbranch_scc1 Lnw_91
    buffer_wbl2 sc1
    s_waitcnt vmcnt(0)
    s_mov_b32 s67, 1
Lnw_91:
    s_sleep 16
    buffer_load_dwordx4 v[64:67], v34, s[40:43], s52 offen offset:0 sc1
    buffer_load_dwordx4 v[68:71], v34, s[40:43], s52 offen offset:2048 sc1
    buffer_load_dwordx4 v[72:75], v34, s[40:43], s54 offen offset:0 sc1
    buffer_load_dwordx4 v[76:79], v34, s[40:43], s54 offen offset:2048 sc1
    buffer_load_dwordx4 v[80:83], v34, s[40:43], s55 offen offset:0 sc1
    buffer_load_dwordx4 v[84:87], v34, s[40:43], s55 offen offset:2048 sc1
    buffer_load_dwordx4 v[88:91], v34, s[40:43], s56 offen offset:0 sc1
    buffer_load_dwordx4 v[92:95], v34, s[40:43], s56 offen offset:2048 sc1
    s_waitcnt vmcnt(0)
    s_branch Lchk_89
Ldone_90:
    s_mov_b64 exec, -1
    v_add_f32 v64, v64, v68
    v_add_f32 v66, v66, v70
    v_add_f32 v72, v72, v76
    v_add_f32 v74, v74, v78
    v_add_f32 v80, v80, v84
    v_add_f32 v82, v82, v86
    v_add_f32 v88, v88, v92
    v_add_f32 v90, v90, v94
    v_add_f32 v64, v64, v72
    v_add_f32 v66, v66, v74
    v_add_f32 v80, v80, v88
    v_add_f32 v82, v82, v90
    v_add_f32 v64, v64, v80
    v_add_f32 v66, v66, v82
    v_cvt_pk_bf16_f32 v8, v64, v66
    v_mov_b32 v9, v8
    s_nop 1
    v_permlane32_swap_b32 v8, v9
    v_lshlrev_b32 v10, 16, v8
    v_and_b32 v8, 0xffff0000, v8
    v_lshlrev_b32 v11, 16, v9
    v_and_b32 v9, 0xffff0000, v9
    v_max_f32 v10, 0, v10
    v_max_f32 v8, 0, v8
    v_mul_f32 v10, v10, v11
    v_mul_f32 v8, v8, v9
    v_cvt_pk_bf16_f32 v8, v10, v8
    s_mov_b32 exec_hi, 0
    ds_write_b32 v1, v8 offset:64
    s_mov_b64 exec, -1
    v_mov_b32 v8, 16
    v_mov_b32 v9, 1
    s_waitcnt lgkmcnt(0)
    s_mov_b64 exec, 1
    ds_add_u32 v8, v9
    s_mov_b64 exec, -1
    v_lshlrev_b32 v10, 7, v0
    s_lshl_b32 s54, s2, 12
    s_add_u32 s54, s54, 1048576
    s_lshl_b32 s56, s68, 6
    s_add_u32 s56, s56, s74
    s_lshl_b32 s56, s56, 11
    s_add_u32 s56, s56, 2097152
    s_mov_b32 exec_hi, 0
    s_mov_b32 exec_lo, 0xffff
    buffer_load_dword v130, v10, s[40:43], s56 offen
    s_mov_b64 exec, -1
    s_lshl_b32 s61, s2, 6
    s_add_u32 s61, s61, 32768
    s_lshl_b32 s50, s48, 12
    s_add_u32 s50, s50, 32768
    v_mov_b32 v8, 12
    s_mov_b32 s60, 0
Lw_92:
    ds_read_b32 v9, v8
    s_waitcnt lgkmcnt(0)
    v_readfirstlane_b32 s53, v9
    s_cmp_ge_u32 s53, 8
    s_cbranch_scc1 Lwd_93
    s_add_u32 s60, s60, 1
    s_cmp_gt_u32 s60, 0x400000
    s_cbranch_scc1 Lwd_93
    s_sleep 4
    s_branch Lw_92
Lwd_93:
    ds_read_b64 v[16:17], v32 offset:14720
    s_waitcnt lgkmcnt(0)
    v_mov_b32 v12, v16
    s_nop 1
    v_max_f32_dpp v12, v12, v12 row_ror:8 row_mask:0xf bank_mask:0xf
    v_mov_b32 v11, v12
    s_nop 1
    v_permlane16_swap_b32 v12, v11
    v_max_f32 v12, v12, v11
    v_mov_b32 v11, v12
    s_nop 1
    v_permlane32_swap_b32 v12, v11
    v_max_f32 v12, v12, v11
    v_sub_f32 v11, v16, v12
    v_exp_f32 v11, v11
    s_nop 0
    v_mul_f32 v17, v17, v11
    s_nop 1
    v_add_f32_dpp v17, v17, v17 row_ror:8 row_mask:0xf bank_mask:0xf
    v_mov_b32 v11, v17
    s_nop 1
    v_permlane16_swap_b32 v17, v11
    v_add_f32 v17, v17, v11
    v_mov_b32 v11, v17
    s_nop 1
    v_permlane32_swap_b32 v17, v11
    v_add_f32 v17, v17, v11
    v_log_f32 v13, v17
    s_nop 0
    v_add_f32 v12, v12, v13
    v_mov_b32 v13, v3
    s_mov_b64 exec, 255
    buffer_store_dwordx2 v[12:13], v32, s[40:43], s61 offen sc1
    s_mov_b64 exec, -1
    v_mov_b32 v8, 24
    s_mov_b32 s60, 0
Lw_94:
    ds_read_b32 v9, v8
    s_waitcnt lgkmcnt(0)
    v_readfirstlane_b32 s53, v9
    s_cmp_ge_u32 s53, 6
    s_cbranch_scc1 Lwd_95
    s_add_u32 s60, s60, 1
    s_cmp_gt_u32 s60, 0x400000
    s_cbranch_scc1 Lwd_95
    s_sleep 4
    s_branch Lw_94
Lwd_95:
    s_mov_b32 s60, 0
    buffer_load_dwordx2 v[64:65], v32, s[40:43], s50 offen offset:0 sc1
    buffer_load_dwordx2 v[66:67], v32, s[40:43], s50 offen offset:512 sc1
    buffer_load_dwordx2 v[68:69], v32, s[40:43], s50 offen offset:1024 sc1
    buffer_load_dwordx2 v[70:71], v32, s[40:43], s50 offen offset:1536 sc1
    buffer_load_dwordx2 v[72:73], v32, s[40:43], s50 offen offset:2048 sc1
    buffer_load_dwordx2 v[74:75], v32, s[40:43], s50 offen offset:2560 sc1
    buffer_load_dwordx2 v[76:77], v32, s[40:43], s50 offen offset:3072 sc1
    buffer_load_dwordx2 v[78:79], v32, s[40:43], s50 offen offset:3584 sc1
    s_waitcnt vmcnt(0)
Lchk_96:
    v_xor_b32 v8, v65, v3
    v_xor_b32 v9, v67, v3
    v_or_b32 v8, v8, v9
    v_xor_b32 v9, v69, v3
    v_or_b32 v8, v8, v9
    v_xor_b32 v9, v71, v3
    v_or_b32 v8, v8, v9
    v_xor_b32 v9, v73, v3
    v_or_b32 v8, v8, v9
    v_xor_b32 v9, v75, v3
    v_or_b32 v8, v8, v9
    v_xor_b32 v9, v77, v3
    v_or_b32 v8, v8, v9
    v_xor_b32 v9, v79, v3
    v_or_b32 v8, v8, v9
    v_cmp_ne_u32 vcc, 0, v8
    s_and_b64 exec, exec, vcc
    s_cbranch_scc0 Ldone_97
    s_add_u32 s60, s60, 1
    s_cmp_gt_u32 s60, 0x40000
    s_cbranch_scc1 Ldone_97
    s_and_b32 s53, s60, 7
    s_cbranch_scc1 Lnw_98
    buffer_wbl2 sc1
    s_waitcnt vmcnt(0)
    s_mov_b32 s67, 1
Lnw_98:
    s_sleep 16
    buffer_load_dwordx2 v[64:65], v32, s[40:43], s50 offen offset:0 sc1
    buffer_load_dwordx2 v[66:67], v32, s[40:43], s50 offen offset:512 sc1
    buffer_load_dwordx2 v[68:69], v32, s[40:43], s50 offen offset:1024 sc1
    buffer_load_dwordx2 v[70:71], v32, s[40:43], s50 offen offset:1536 sc1
    buffer_load_dwordx2 v[72:73], v32, s[40:43], s50 offen offset:2048 sc1
    buffer_load_dwordx2 v[74:75], v32, s[40:43], s50 offen offset:2560 sc1
    buffer_load_dwordx2 v[76:77], v32, s[40:43], s50 offen offset:3072 sc1
    buffer_load_dwordx2 v[78:79], v32, s[40:43], s50 offen offset:3584 sc1
    s_waitcnt vmcnt(0)
    s_branch Lchk_96
Ldone_97:
    s_mov_b64 exec, -1
    v_max3_f32 v40, v64, v66, v68
    v_max3_f32 v40, v40, v70, v72
    v_max3_f32 v40, v40, v74, v76
    v_max_f32 v40, v40, v78
    s_nop 1
    v_max_f32_dpp v40, v40, v40 row_ror:8 row_mask:0xf bank_mask:0xf
    v_mov_b32 v11, v40
    s_nop 1
    v_permlane16_swap_b32 v40, v11
    v_max_f32 v40, v40, v11
    v_mov_b32 v11, v40
    s_nop 1
    v_permlane32_swap_b32 v40, v11
    v_max_f32 v40, v40, v11
    v_sub_f32 v64, v64, v40
    v_sub_f32 v66, v66, v40
    v_sub_f32 v68, v68, v40
    v_sub_f32 v70, v70, v40
    v_sub_f32 v72, v72, v40
    v_sub_f32 v74, v74, v40
    v_sub_f32 v76, v76, v40
    v_sub_f32 v78, v78, v40
    v_exp_f32 v64, v64
    v_exp_f32 v66, v66
    v_exp_f32 v68, v68
    v_exp_f32 v70, v70
    v_exp_f32 v72, v72
    v_exp_f32 v74, v74
    v_exp_f32 v76, v76
    v_exp_f32 v78, v78
    v_add_f32 v41, v64, v66
    v_add_f32 v41, v41, v68
    v_add_f32 v41, v41, v70
    v_add_f32 v41, v41, v72
    v_add_f32 v41, v41, v74
    v_add_f32 v41, v41, v76
    v_add_f32 v41, v41, v78
    s_nop 1
    v_add_f32_dpp v41, v41, v41 row_ror:8 row_mask:0xf bank_mask:0xf
    v_mov_b32 v11, v41
    s_nop 1
    v_permlane16_swap_b32 v41, v11
    v_add_f32 v41, v41, v11
    v_mov_b32 v11, v41
    s_nop 1
    v_permlane32_swap_b32 v41, v11
    v_add_f32 v41, v41, v11
    v_sub_f32 v9, v16, v40
    v_exp_f32 v9, v9
    v_rcp_f32 v10, v41
    s_nop 0
    v_mul_f32 v9, v9, v10
    v_and_b32 v10, 7, v0
    v_lshlrev_b32 v10, 5, v10
    v_lshrrev_b32 v11, 3, v0
    v_lshl_add_u32 v10, v11, 2, v10
    ds_write_b32 v10, v9 offset:15232
    s_waitcnt lgkmcnt(0)
    s_endpgm
.section .rodata,"a"
.p2align 6
.amdhsa_kernel gated_mix__gqa_block_cached__glu_gated_reglu__decode_kernel
  .amdhsa_next_free_vgpr 168
  .amdhsa_next_free_sgpr 102
  .amdhsa_accum_offset 168
  .amdhsa_group_segment_fixed_size 0
  .amdhsa_kernarg_size 104
  .amdhsa_user_sgpr_count 2
  .amdhsa_user_sgpr_kernarg_segment_ptr 1
  .amdhsa_system_sgpr_workgroup_id_x 1
  .amdhsa_float_denorm_mode_32 3
  .amdhsa_float_denorm_mode_16_64 3
.end_amdhsa_kernel
```
